```python
import torch

def _softmax(x, axis=-1):
    return torch.softmax(x, dim=axis)
def _gelu(x):
    return torch.nn.functional.gelu(x, approximate="tanh")
def _silu(x):
    return torch.nn.functional.silu(x)
def _sigmoid(x):
    return torch.sigmoid(x)
def _layernorm(x, axis=-1, eps=1e-5):
    m = x.mean(dim=axis, keepdim=True)
    v = x.var(dim=axis, keepdim=True, unbiased=False)
    return (x - m) / torch.sqrt(v + eps)
def _scatter_add(tgt, idx, src, axis=0):
    return tgt.clone().index_add_(axis, idx, src)
def _segment_sum(src, seg, n):
    out = torch.zeros((n,) + src.shape[1:], dtype=src.dtype)
    return out.index_add_(0, seg, src)
def _pad(x, pw):
    flat = tuple(v for pair in reversed(pw) for v in pair)
    return torch.nn.functional.pad(x, flat)

kernel_name = 'gated_mix__mha_block__linear_attn_block__prompt'

def setup_inputs():

    _w = (lambda a: (lambda t: t.to(torch.bfloat16) if t.is_floating_point() else t)(torch.as_tensor(a)))
    def _A_setup():
        B, S, D, H = 1, 2048, 512, 32
        return {
            "x": _w((lambda *s: torch.randn(*s, dtype=torch.bfloat16) * 0.05)(B, S, D)),
            "wqkv": _w((lambda *s: torch.randn(*s, dtype=torch.bfloat16) * 0.8)(D, 3 * D)),
            "wo": _w((lambda *s: torch.randn(*s, dtype=torch.bfloat16) * 0.05)(D, D)),
        }
    _A_in = _A_setup()

    def _B_setup():
        B, S, D = 1, 2048, 512
        return {
            "x": _w((lambda *s: torch.randn(*s, dtype=torch.bfloat16) * 0.05)(B, S, D)),
            "wqkv": _w((lambda *s: torch.randn(*s, dtype=torch.bfloat16) * 0.8)(D, 3 * D)),
            "wo": _w((lambda *s: torch.randn(*s, dtype=torch.bfloat16) * 0.2)(D, D)),
        }
    _B_in = _B_setup()

    return {
        "A_x": _A_in["x"],
        "A_wqkv": _A_in["wqkv"],
        "A_wo": _A_in["wo"],
        "B_x": _B_in["x"],
        "B_wqkv": _B_in["wqkv"],
        "B_wo": _B_in["wo"],
        "gate_w": _w((lambda *s: torch.randn(*s, dtype=torch.bfloat16) * 0.05)(512) * 16.0),
    }

def reference(A_x, A_wqkv, A_wo, B_x, B_wqkv, B_wo, gate_w):
    def _A_ref(x, wqkv, wo):
        B, S, D = x.shape
        H = 32
        Dh = D // H
        qkv = (lambda x, *d: x.permute(*d))((x @ wqkv).reshape(B, S, 3, H, Dh), 2, 0, 3, 1, 4)
        q, k, v = qkv[0], qkv[1], qkv[2]
        scores = torch.einsum("bhqd,bhkd->bhqk", q, k) * (Dh ** -0.5)
        p = _softmax(scores, axis=-1)
        o = torch.einsum("bhqk,bhkd->bhqd", p, v)
        return (lambda x, *d: x.permute(*d))(o, 0, 2, 1, 3).reshape(B, S, D) @ wo

    def _B_ref(x, wqkv, wo):
        B, S, D = x.shape
        H = 32; Dh = D // H
        qkv = (lambda x, *d: x.permute(*d))((x @ wqkv).reshape(B, S, 3, H, Dh), 2, 0, 3, 1, 4)
        q, k, v = qkv[0], qkv[1], qkv[2]
        phi = lambda t: torch.where(t > 0, t + 1, torch.exp(t)) + 1e-6
        pq, pk = phi(q), phi(k)
        kv = torch.einsum("bhsd,bhse->bhde", pk, v)
        z = torch.einsum("bhsd->bhd", pk)
        num = torch.einsum("bhqd,bhde->bhqe", pq, kv)
        den = torch.einsum("bhqd,bhd->bhq", pq, z)[..., None] + 1e-6
        o = num / den
        return (lambda x, *d: x.permute(*d))(o, 0, 2, 1, 3).reshape(B, S, D) @ wo

    x = A_x
    g = _sigmoid((x * gate_w).sum(-1, keepdims=True))
    a = _A_ref(x, A_wqkv, A_wo)
    b = _B_ref(x, B_wqkv, B_wo)
    return g * a + (1 - g) * b
```

```asm
; @launch grid=(256,1,1) block=(512,1,1) lds=163840
.amdgcn_target "amdgcn-amd-amdhsa--gfx950"
.text
.globl gated_mix__mha_block__linear_attn_block__prompt_kernel
.p2align 8
.type gated_mix__mha_block__linear_attn_block__prompt_kernel,@function
gated_mix__mha_block__linear_attn_block__prompt_kernel:
    s_cmp_ge_u32 s2, 256
    s_cbranch_scc1 L_end
    s_load_dwordx2 s[12:13], s[0:1], 0
    s_load_dwordx2 s[16:17], s[0:1], 8
    s_load_dwordx2 s[8:9], s[0:1], 72
    s_load_dwordx2 s[20:21], s[0:1], 32
    s_load_dwordx2 s[24:25], s[0:1], 48
    s_load_dwordx2 s[28:29], s[0:1], 16
    s_load_dwordx2 s[32:33], s[0:1], 40
    s_load_dwordx2 s[36:37], s[0:1], 56
    v_lshrrev_b32 v3, 6, v0
    v_and_b32 v1, 63, v0
    s_and_b32 s4, s2, 7
    v_readfirstlane_b32 s44, v3
    s_lshr_b32 s5, s2, 3
    v_lshlrev_b32 v2, 4, v1
    s_and_b32 s45, s5, 15
    s_and_b32 s6, s4, 1
    s_lshl_b32 s6, s6, 4
    s_add_u32 s45, s45, s6
    s_lshr_b32 s46, s5, 4
    s_and_b32 s6, s4, 6
    s_add_u32 s46, s46, s6
    s_mov_b32 s14, 0x200000
    s_mov_b32 s15, 0x20000
    s_mov_b32 s18, 0x180000
    s_mov_b32 s19, 0x20000
    s_cmp_lt_u32 s44, 4
    s_cbranch_scc1 L_compute
    s_sub_u32 s60, s44, 4
    v_lshrrev_b32 v8, 3, v1
    v_and_b32 v9, 7, v1
    v_lshrrev_b32 v10, 4, v1
    v_xor_b32 v4, v9, v10
    v_lshlrev_b32 v4, 4, v4
    v_lshl_add_u32 v4, v8, 10, v4
    v_xor_b32 v5, 64, v4
    v_and_b32 v10, 1, v10
    v_lshlrev_b32 v10, 1, v10
    v_xor_b32 v6, v9, v10
    v_lshlrev_b32 v6, 4, v6
    v_mul_u32_u24 v8, 0xc00, v8
    v_xor_b32 v7, 64, v6
    v_add_u32 v6, v6, v8
    v_add_u32 v7, v7, v8
    s_lshl_b32 s61, s45, 16
    s_lshl_b32 s50, s60, 14
    s_add_u32 s61, s61, s50
    s_mul_i32 s62, s60, 49152
    s_lshl_b32 s64, s60, 11
    s_add_u32 s63, s64, 98304
    s_and_b32 s50, s46, 1
    s_lshl_b32 s50, s50, 2
    s_add_u32 s65, s50, s45
    s_add_u32 s40, s46, 0
    s_and_b32 s40, s40, 7
    s_lshl_b32 s40, s40, 7
    s_add_u32 s41, s46, 2
    s_and_b32 s41, s41, 7
    s_lshl_b32 s41, s41, 7
    s_add_u32 s42, s46, 4
    s_and_b32 s42, s42, 7
    s_lshl_b32 s42, s42, 7
    s_add_u32 s43, s46, 6
    s_and_b32 s43, s43, 7
    s_lshl_b32 s43, s43, 7
    s_add_u32 s96, s46, 1
    s_and_b32 s96, s96, 7
    s_lshl_b32 s96, s96, 7
    s_waitcnt lgkmcnt(0)
    s_add_u32 s94, s65, 0
    s_and_b32 s94, s94, 7
    s_mul_i32 s94, s94, 128
    s_add_u32 s94, s94, s61
    s_add_u32 m0, s63, 0
    s_add_u32 s50, s94, 0
    buffer_load_dwordx4 v4, s[12:15], s50 offen lds
    s_add_u32 m0, s63, 1024
    s_add_u32 s50, s94, 8192
    buffer_load_dwordx4 v5, s[12:15], s50 offen lds
    s_add_u32 s51, s65, 0
    s_and_b32 s51, s51, 7
    s_mul_i32 s51, s51, 196608
    s_add_u32 s51, s51, s62
    s_add_u32 s95, s51, s40
    s_add_u32 s97, s51, s41
    s_add_u32 s66, s51, s42
    s_add_u32 m0, s64, 0
    s_add_u32 s50, s95, 0
    buffer_load_dwordx4 v6, s[16:19], s50 offen lds
    s_add_u32 m0, s64, 8192
    s_add_u32 s50, s97, 1024
    buffer_load_dwordx4 v6, s[16:19], s50 offen lds
    s_add_u32 m0, s64, 16384
    s_add_u32 s50, s66, 2048
    buffer_load_dwordx4 v6, s[16:19], s50 offen lds
    s_add_u32 m0, s64, 1024
    s_add_u32 s50, s95, 24576
    buffer_load_dwordx4 v7, s[16:19], s50 offen lds
    s_add_u32 m0, s64, 9216
    s_add_u32 s50, s97, 25600
    buffer_load_dwordx4 v7, s[16:19], s50 offen lds
    s_add_u32 m0, s64, 17408
    s_add_u32 s50, s66, 26624
    buffer_load_dwordx4 v7, s[16:19], s50 offen lds
    s_mov_b32 s10, 0x1000000
    s_mov_b32 s11, 0x20000
    s_mov_b32 s22, 0x180000
    s_mov_b32 s23, 0x20000
    s_mov_b32 s26, 0x400
    s_mov_b32 s27, 0x20000
    s_mov_b32 s30, 0x80000
    s_mov_b32 s31, 0x20000
    s_mov_b32 s34, 0x80000
    s_mov_b32 s35, 0x20000
    s_mov_b32 s38, 0x200000
    s_mov_b32 s39, 0x20000
    v_bfe_u32 v11, v1, 1, 3
    v_add_u32 v11, s65, v11
    v_and_b32 v11, 7, v11
    v_lshlrev_b32 v11, 7, v11
    v_and_b32 v12, 1, v1
    v_lshl_add_u32 v11, v12, 6, v11
    v_and_b32 v12, 48, v1
    v_add_u32 v11, v11, v12
    buffer_load_dwordx4 v[28:31], v11, s[24:27], 0 offen
    s_and_b32 s4, s45, 15
    s_lshl_b32 s4, s4, 2
    s_add_u32 s4, s4, s60
    v_lshl_add_u32 v34, v1, 6, s4
    v_mul_u32_u24 v32, 0xaaab, v34
    v_lshrrev_b32 v32, 17, v32
    v_mul_u32_u24 v32, 3, v32
    v_cmp_eq_u32 vcc, v32, v34
    v_mov_b32 v32, s43
    v_mov_b32 v33, s96
    v_cndmask_b32 v32, v33, v32, vcc
    v_lshl_add_u32 v34, v34, 10, v32
    s_add_u32 s6, s8, 14909440
    s_addc_u32 s7, s9, 0
    s_load_dword s49, s[6:7], 0
    s_add_u32 s94, s65, 1
    s_and_b32 s94, s94, 7
    s_mul_i32 s94, s94, 128
    s_add_u32 s94, s94, s61
    s_add_u32 m0, s63, 8192
    s_add_u32 s50, s94, 0
    buffer_load_dwordx4 v4, s[12:15], s50 offen lds
    s_add_u32 m0, s63, 9216
    s_add_u32 s50, s94, 8192
    buffer_load_dwordx4 v5, s[12:15], s50 offen lds
    s_add_u32 s94, s65, 2
    s_and_b32 s94, s94, 7
    s_mul_i32 s94, s94, 128
    s_add_u32 s94, s94, s61
    s_add_u32 m0, s63, 16384
    s_add_u32 s50, s94, 0
    buffer_load_dwordx4 v4, s[12:15], s50 offen lds
    s_add_u32 m0, s63, 17408
    s_add_u32 s50, s94, 8192
    buffer_load_dwordx4 v5, s[12:15], s50 offen lds
    s_add_u32 s94, s65, 3
    s_and_b32 s94, s94, 7
    s_mul_i32 s94, s94, 128
    s_add_u32 s94, s94, s61
    s_add_u32 m0, s63, 24576
    s_add_u32 s50, s94, 0
    buffer_load_dwordx4 v4, s[12:15], s50 offen lds
    s_add_u32 m0, s63, 25600
    s_add_u32 s50, s94, 8192
    buffer_load_dwordx4 v5, s[12:15], s50 offen lds
    s_and_b32 s4, s2, 7
    s_lshr_b32 s5, s2, 3
    s_lshl_b32 s47, s4, 2
    s_and_b32 s6, s5, 3
    s_add_u32 s47, s47, s6
    s_lshr_b32 s48, s5, 2
    s_lshl_b32 s59, s47, 16
    s_lshl_b32 s68, s4, 2
    s_lshr_b32 s6, s2, 6
    s_add_u32 s68, s68, s6
    s_and_b32 s69, s5, 7
    s_and_b32 s71, s44, 1
    s_lshr_b32 s70, s44, 1
    s_mov_b32 s52, 0x3fb8aa3b
    s_mov_b32 s53, 0x3fb8aa3b
    s_mov_b32 s54, 0x358637bd
    s_mov_b32 s55, 0x358637bd
    s_mov_b32 s56, 0xffff
    s_mov_b32 s57, 0xffff
    s_lshr_b32 s4, s44, 2
    s_and_b32 s5, s44, 3
    s_lshl_b32 s5, s5, 1
    s_add_u32 s5, s5, s4
    s_lshl_b32 s58, s48, 3
    s_add_u32 s58, s58, s5
    s_lshl_b32 s5, s5, 10
    s_add_u32 s5, s5, 65536
    v_add_u32 v228, s5, v2
    s_lshl_b32 s4, s4, 12
    v_add_u32 v226, s4, v2
    v_and_b32 v246, 15, v1
    v_lshrrev_b32 v247, 5, v1
    v_lshl_add_u32 v246, v247, 4, v246
    s_add_u32 s4, s4, 8192
    v_lshl_add_u32 v227, v246, 4, s4
    v_mov_b32 v3, 0xdddd
    v_mov_b32 v252, 0
    v_lshlrev_b32 v253, 10, v1
    v_and_b32 v246, 31, v1
    s_lshr_b32 s4, s47, 2
    s_sub_u32 s5, s4, 2
    s_and_b32 s5, s5, 7
    s_lshl_b32 s5, s5, 11
    s_sub_u32 s6, s4, 4
    s_and_b32 s6, s6, 7
    s_lshl_b32 s6, s6, 11
    v_mov_b32 v248, s5
    v_mov_b32 v249, s6
    v_cmp_gt_u32 vcc, 32, v1
    s_sub_u32 s5, s4, 1
    s_and_b32 s5, s5, 7
    v_cndmask_b32 v248, v249, v248, vcc
    v_lshl_add_u32 v229, v246, 4, v248
    s_lshl_b32 s5, s5, 9
    v_lshl_add_u32 v248, v246, 4, s5
    s_sub_u32 s6, s4, 6
    s_and_b32 s6, s6, 7
    s_lshl_b32 s78, s6, 14
    s_lshl_b32 s6, s6, 5
    s_lshr_b32 s5, s58, 1
    s_add_u32 s6, s6, s5
    s_lshl_b32 s6, s6, 4
    v_mov_b32 v249, s6
    v_cndmask_b32 v230, v249, v248, vcc
    v_lshlrev_b32 v233, 3, v246
    v_lshlrev_b32 v248, 5, v247
    v_lshl_add_u32 v232, v246, 6, v248
    v_add_u32 v248, 0x400, v248
    v_cmp_gt_u32 vcc, 16, v246
    s_lshl_b32 s4, s44, 11
    s_add_u32 s4, s4, 131072
    v_cndmask_b32 v232, v248, v232, vcc
    v_add_u32 v234, s4, v2
    v_add_u32 v235, 131072, v2
    s_lshl_b32 s4, s44, 8
    s_add_u32 s4, s4, 114688
    v_lshl_add_u32 v239, v1, 2, s4
    s_xor_b32 s4, s4, 0x400
    v_lshl_add_u32 v241, v246, 2, s4
    v_xor_b32 v240, 0x2000, v234
    v_lshrrev_b32 v248, 3, v1
    v_and_b32 v249, 7, v1
    v_lshlrev_b32 v231, 4, v249
    v_bfe_u32 v236, v1, 4, 1
    v_lshlrev_b32 v236, 2, v236
    v_xor_b32 v236, v249, v236
    v_lshlrev_b32 v236, 4, v236
    v_lshl_add_u32 v236, v248, 10, v236
    v_lshlrev_b32 v242, 4, v249
    v_lshl_add_u32 v242, v246, 8, v242
    v_bfe_u32 v249, v1, 1, 1
    v_xor_b32 v249, v249, v247
    v_lshl_add_u32 v242, v249, 7, v242
    s_lshl_b32 s4, s70, 14
    s_lshl_b32 s5, s71, 13
    s_add_u32 s5, s5, s4
    v_add_u32 v242, s5, v242
    v_bfe_u32 v248, v1, 2, 2
    v_lshl_add_u32 v248, v247, 2, v248
    v_lshlrev_b32 v237, 7, v248
    v_bfe_u32 v248, v1, 3, 1
    v_lshl_add_u32 v237, v248, 6, v237
    v_bfe_u32 v248, v1, 4, 1
    v_lshl_add_u32 v237, v248, 5, v237
    v_and_b32 v248, 3, v1
    v_lshl_add_u32 v237, v248, 3, v237
    v_add_u32 v237, s4, v237
    v_xor_b32 v238, 64, v237
    v_lshrrev_b32 v246, 3, v0
    v_and_b32 v247, 7, v0
    v_and_b32 v248, 7, v246
    v_xor_b32 v248, v248, v247
    v_lshlrev_b32 v243, 4, v248
    v_lshl_add_u32 v243, v246, 8, v243
    v_bfe_u32 v248, v246, 1, 1
    v_lshl_add_u32 v243, v248, 7, v243
    v_xor_b32 v244, 0x80, v243
    v_lshlrev_b32 v245, 4, v247
    v_lshl_add_u32 v245, v246, 10, v245
    s_lshl_b32 s5, s71, 11
    s_lshl_b32 s73, s70, 12
    s_add_u32 s73, s73, s5
    s_add_u32 s72, s59, s5
    s_and_b32 s5, s70, 1
    s_lshl_b32 s5, s5, 15
    s_add_u32 s72, s72, s5
    s_lshr_b32 s5, s70, 1
    s_lshl_b32 s5, s5, 21
    s_add_u32 s72, s72, s5
    s_add_u32 s72, s72, 2097152
    s_lshl_b32 s5, s46, 5
    s_add_u32 s5, s5, s45
    s_lshl_b32 s5, s5, 4
    s_add_u32 s74, s5, 15073280
    s_mov_b32 s75, 15073280
    s_lshl_b32 s5, s58, 8
    s_add_u32 s78, s78, s5
    s_add_u32 s78, s78, 14680064
    s_mul_i32 s4, s47, 34816
    s_mul_i32 s5, s44, 4352
    s_add_u32 s4, s4, s5
    s_add_u32 s76, s4, 12582912
    s_lshl_b32 s4, s58, 10
    s_add_u32 s4, s4, s59
    s_add_u32 s77, s4, 6291456
    s_lshl_b32 s4, s58, 2
    s_add_u32 s4, s4, s47
    s_and_b32 s4, s4, 31
    s_lshl_b32 s4, s4, 10
    s_lshl_b32 s5, s58, 15
    s_add_u32 s4, s4, s5
    s_add_u32 s79, s4, 10485760
    s_add_u32 s80, s4, 8388608
    s_lshl_b32 s4, s58, 5
    s_add_u32 s4, s4, s47
    s_lshl_b32 s4, s4, 4
    s_add_u32 s81, s4, 15204352
    s_lshl_b32 s6, s69, 7
    s_lshr_b32 s4, s2, 6
    s_lshl_b32 s4, s4, 17
    s_lshl_b32 s5, s44, 14
    s_add_u32 s4, s4, s5
    s_add_u32 s82, s4, s6
    s_lshl_b32 s84, s44, 10
    s_lshl_b32 s4, s44, 13
    s_add_u32 s83, s4, s6
    s_lshl_b32 s4, s68, 16
    s_add_u32 s90, s4, s6
    s_lshl_b32 s6, s68, 1
    s_add_u32 s6, s6, s71
    s_lshl_b32 s4, s6, 2
    s_add_u32 s4, s4, s70
    s_lshl_b32 s4, s4, 7
    s_add_u32 s85, s4, 15204352
    s_lshl_b32 s4, s70, 1
    s_add_u32 s4, s4, s6
    s_lshl_b32 s6, s6, 15
    s_and_b32 s5, s4, 7
    s_lshl_b32 s5, s5, 12
    s_add_u32 s5, s5, s6
    s_add_u32 s86, s5, 10485760
    s_add_u32 s88, s5, 8388608
    s_add_u32 s4, s4, 1
    s_and_b32 s5, s4, 7
    s_lshl_b32 s5, s5, 12
    s_add_u32 s5, s5, s6
    s_add_u32 s87, s5, 10485760
    s_add_u32 s89, s5, 8388608
    v_mov_b32 v84, 0
    v_mov_b32 v85, 0
    v_mov_b32 v86, 0
    v_mov_b32 v87, 0
    v_mov_b32 v88, 0
    v_mov_b32 v89, 0
    v_mov_b32 v90, 0
    v_mov_b32 v91, 0
    v_mov_b32 v92, 0
    v_mov_b32 v93, 0
    v_mov_b32 v94, 0
    v_mov_b32 v95, 0
    v_mov_b32 v96, 0
    v_mov_b32 v97, 0
    v_mov_b32 v98, 0
    v_mov_b32 v99, 0
    s_mov_b32 exec_lo, 0x00010000
    s_mov_b32 exec_hi, 0x00010000
    v_mov_b32 v84, 0x3f803f80
    v_mov_b32 v85, 0x3f803f80
    v_mov_b32 v86, 0x3f803f80
    v_mov_b32 v87, 0x3f803f80
    v_mov_b32 v88, 0x3f803f80
    v_mov_b32 v89, 0x3f803f80
    v_mov_b32 v90, 0x3f803f80
    v_mov_b32 v91, 0x3f803f80
    v_mov_b32 v92, 0x3f803f80
    v_mov_b32 v93, 0x3f803f80
    v_mov_b32 v94, 0x3f803f80
    v_mov_b32 v95, 0x3f803f80
    v_mov_b32 v96, 0x3f803f80
    v_mov_b32 v97, 0x3f803f80
    v_mov_b32 v98, 0x3f803f80
    v_mov_b32 v99, 0x3f803f80
    s_mov_b64 exec, -1
    v_mov_b32 v44, 0
    v_mov_b32 v45, 0
    v_mov_b32 v46, 0
    v_mov_b32 v47, 0
    v_mov_b32 v48, 0
    v_mov_b32 v49, 0
    v_mov_b32 v50, 0
    v_mov_b32 v51, 0
    v_mov_b32 v52, 0
    v_mov_b32 v53, 0
    v_mov_b32 v54, 0
    v_mov_b32 v55, 0
    v_mov_b32 v56, 0
    v_mov_b32 v57, 0
    v_mov_b32 v58, 0
    v_mov_b32 v59, 0
    v_mov_b32 v60, 0
    v_mov_b32 v61, 0
    v_mov_b32 v62, 0
    v_mov_b32 v63, 0
    v_mov_b32 v64, 0
    v_mov_b32 v65, 0
    v_mov_b32 v66, 0
    v_mov_b32 v67, 0
    v_mov_b32 v68, 0
    v_mov_b32 v69, 0
    v_mov_b32 v70, 0
    v_mov_b32 v71, 0
    v_mov_b32 v72, 0
    v_mov_b32 v73, 0
    v_mov_b32 v74, 0
    v_mov_b32 v75, 0
    s_waitcnt vmcnt(7)
    s_barrier
    s_add_u32 s51, s65, 1
    s_and_b32 s51, s51, 7
    s_mul_i32 s51, s51, 196608
    s_add_u32 s51, s51, s62
    s_add_u32 s95, s51, s40
    s_add_u32 s97, s51, s41
    s_add_u32 s66, s51, s42
    s_add_u32 m0, s64, 24576
    s_add_u32 s50, s95, 0
    buffer_load_dwordx4 v6, s[16:19], s50 offen lds
    s_add_u32 m0, s64, 32768
    s_add_u32 s50, s97, 1024
    buffer_load_dwordx4 v6, s[16:19], s50 offen lds
    s_add_u32 m0, s64, 40960
    s_add_u32 s50, s66, 2048
    buffer_load_dwordx4 v6, s[16:19], s50 offen lds
    s_add_u32 m0, s64, 25600
    s_add_u32 s50, s95, 24576
    buffer_load_dwordx4 v7, s[16:19], s50 offen lds
    s_add_u32 m0, s64, 33792
    s_add_u32 s50, s97, 25600
    buffer_load_dwordx4 v7, s[16:19], s50 offen lds
    s_add_u32 m0, s64, 41984
    s_add_u32 s50, s66, 26624
    buffer_load_dwordx4 v7, s[16:19], s50 offen lds
    s_add_u32 s51, s65, 2
    s_and_b32 s51, s51, 7
    s_mul_i32 s51, s51, 196608
    s_add_u32 s51, s51, s62
    s_add_u32 s95, s51, s40
    s_add_u32 s97, s51, s41
    s_add_u32 s66, s51, s42
    s_add_u32 m0, s64, 49152
    s_add_u32 s50, s95, 0
    buffer_load_dwordx4 v6, s[16:19], s50 offen lds
    s_add_u32 m0, s64, 57344
    s_add_u32 s50, s97, 1024
    buffer_load_dwordx4 v6, s[16:19], s50 offen lds
    s_add_u32 m0, s64, 65536
    s_add_u32 s50, s66, 2048
    buffer_load_dwordx4 v6, s[16:19], s50 offen lds
    s_add_u32 m0, s64, 50176
    s_add_u32 s50, s95, 24576
    buffer_load_dwordx4 v7, s[16:19], s50 offen lds
    s_add_u32 m0, s64, 58368
    s_add_u32 s50, s97, 25600
    buffer_load_dwordx4 v7, s[16:19], s50 offen lds
    s_add_u32 m0, s64, 66560
    s_add_u32 s50, s66, 26624
    buffer_load_dwordx4 v7, s[16:19], s50 offen lds
    s_waitcnt vmcnt(6)
    s_barrier
    s_add_u32 s94, s65, 4
    s_and_b32 s94, s94, 7
    s_mul_i32 s94, s94, 128
    s_add_u32 s94, s94, s61
    s_add_u32 m0, s63, 32768
    s_add_u32 s50, s94, 0
    buffer_load_dwordx4 v4, s[12:15], s50 offen lds
    s_add_u32 m0, s63, 33792
    s_add_u32 s50, s94, 8192
    buffer_load_dwordx4 v5, s[12:15], s50 offen lds
    s_add_u32 s94, s65, 5
    s_and_b32 s94, s94, 7
    s_mul_i32 s94, s94, 128
    s_add_u32 s94, s94, s61
    s_add_u32 m0, s63, 40960
    s_add_u32 s50, s94, 0
    buffer_load_dwordx4 v4, s[12:15], s50 offen lds
    s_add_u32 m0, s63, 41984
    s_add_u32 s50, s94, 8192
    buffer_load_dwordx4 v5, s[12:15], s50 offen lds
    s_add_u32 s51, s65, 3
    s_and_b32 s51, s51, 7
    s_mul_i32 s51, s51, 196608
    s_add_u32 s51, s51, s62
    s_add_u32 s95, s51, s40
    s_add_u32 s97, s51, s41
    s_add_u32 s66, s51, s42
    s_add_u32 m0, s64, 73728
    s_add_u32 s50, s95, 0
    buffer_load_dwordx4 v6, s[16:19], s50 offen lds
    s_add_u32 m0, s64, 81920
    s_add_u32 s50, s97, 1024
    buffer_load_dwordx4 v6, s[16:19], s50 offen lds
    s_add_u32 m0, s64, 90112
    s_add_u32 s50, s66, 2048
    buffer_load_dwordx4 v6, s[16:19], s50 offen lds
    s_add_u32 m0, s64, 74752
    s_add_u32 s50, s95, 24576
    buffer_load_dwordx4 v7, s[16:19], s50 offen lds
    s_add_u32 m0, s64, 82944
    s_add_u32 s50, s97, 25600
    buffer_load_dwordx4 v7, s[16:19], s50 offen lds
    s_add_u32 m0, s64, 91136
    s_add_u32 s50, s66, 26624
    buffer_load_dwordx4 v7, s[16:19], s50 offen lds
    s_add_u32 s94, s65, 6
    s_and_b32 s94, s94, 7
    s_mul_i32 s94, s94, 128
    s_add_u32 s94, s94, s61
    s_add_u32 m0, s63, 49152
    s_add_u32 s50, s94, 0
    buffer_load_dwordx4 v4, s[12:15], s50 offen lds
    s_add_u32 m0, s63, 50176
    s_add_u32 s50, s94, 8192
    buffer_load_dwordx4 v5, s[12:15], s50 offen lds
    s_add_u32 s51, s65, 4
    s_and_b32 s51, s51, 7
    s_mul_i32 s51, s51, 196608
    s_add_u32 s51, s51, s62
    s_add_u32 s95, s51, s40
    s_add_u32 s97, s51, s41
    s_add_u32 s66, s51, s42
    s_add_u32 m0, s64, 0
    s_add_u32 s50, s95, 0
    buffer_load_dwordx4 v6, s[16:19], s50 offen lds
    s_add_u32 m0, s64, 8192
    s_add_u32 s50, s97, 1024
    buffer_load_dwordx4 v6, s[16:19], s50 offen lds
    s_add_u32 m0, s64, 16384
    s_add_u32 s50, s66, 2048
    buffer_load_dwordx4 v6, s[16:19], s50 offen lds
    s_add_u32 m0, s64, 1024
    s_add_u32 s50, s95, 24576
    buffer_load_dwordx4 v7, s[16:19], s50 offen lds
    s_add_u32 m0, s64, 9216
    s_add_u32 s50, s97, 25600
    buffer_load_dwordx4 v7, s[16:19], s50 offen lds
    s_add_u32 m0, s64, 17408
    s_add_u32 s50, s66, 26624
    buffer_load_dwordx4 v7, s[16:19], s50 offen lds
    s_waitcnt vmcnt(18)
    s_barrier
    v_mov_b32_dpp v100, v28 row_newbcast:0 row_mask:0xf bank_mask:0xf
    v_mov_b32_dpp v101, v29 row_newbcast:0 row_mask:0xf bank_mask:0xf
    v_mov_b32_dpp v102, v30 row_newbcast:0 row_mask:0xf bank_mask:0xf
    v_mov_b32_dpp v103, v31 row_newbcast:0 row_mask:0xf bank_mask:0xf
    v_mov_b32_dpp v104, v28 row_newbcast:1 row_mask:0xf bank_mask:0xf
    v_mov_b32_dpp v105, v29 row_newbcast:1 row_mask:0xf bank_mask:0xf
    v_mov_b32_dpp v106, v30 row_newbcast:1 row_mask:0xf bank_mask:0xf
    v_mov_b32_dpp v107, v31 row_newbcast:1 row_mask:0xf bank_mask:0xf
    v_mov_b32_dpp v108, v28 row_newbcast:2 row_mask:0xf bank_mask:0xf
    v_mov_b32_dpp v109, v29 row_newbcast:2 row_mask:0xf bank_mask:0xf
    v_mov_b32_dpp v110, v30 row_newbcast:2 row_mask:0xf bank_mask:0xf
    v_mov_b32_dpp v111, v31 row_newbcast:2 row_mask:0xf bank_mask:0xf
    v_mov_b32_dpp v112, v28 row_newbcast:3 row_mask:0xf bank_mask:0xf
    v_mov_b32_dpp v113, v29 row_newbcast:3 row_mask:0xf bank_mask:0xf
    v_mov_b32_dpp v114, v30 row_newbcast:3 row_mask:0xf bank_mask:0xf
    v_mov_b32_dpp v115, v31 row_newbcast:3 row_mask:0xf bank_mask:0xf
    s_add_u32 s94, s65, 7
    s_and_b32 s94, s94, 7
    s_mul_i32 s94, s94, 128
    s_add_u32 s94, s94, s61
    s_add_u32 m0, s63, 57344
    s_add_u32 s50, s94, 0
    buffer_load_dwordx4 v4, s[12:15], s50 offen lds
    s_add_u32 m0, s63, 58368
    s_add_u32 s50, s94, 8192
    buffer_load_dwordx4 v5, s[12:15], s50 offen lds
    s_add_u32 s51, s65, 5
    s_and_b32 s51, s51, 7
    s_mul_i32 s51, s51, 196608
    s_add_u32 s51, s51, s62
    s_add_u32 s95, s51, s40
    s_add_u32 s97, s51, s41
    s_add_u32 s66, s51, s42
    s_add_u32 m0, s64, 24576
    s_add_u32 s50, s95, 0
    buffer_load_dwordx4 v6, s[16:19], s50 offen lds
    s_add_u32 m0, s64, 32768
    s_add_u32 s50, s97, 1024
    buffer_load_dwordx4 v6, s[16:19], s50 offen lds
    s_add_u32 m0, s64, 40960
    s_add_u32 s50, s66, 2048
    buffer_load_dwordx4 v6, s[16:19], s50 offen lds
    s_add_u32 m0, s64, 25600
    s_add_u32 s50, s95, 24576
    buffer_load_dwordx4 v7, s[16:19], s50 offen lds
    s_add_u32 m0, s64, 33792
    s_add_u32 s50, s97, 25600
    buffer_load_dwordx4 v7, s[16:19], s50 offen lds
    s_add_u32 m0, s64, 41984
    s_add_u32 s50, s66, 26624
    buffer_load_dwordx4 v7, s[16:19], s50 offen lds
    s_waitcnt vmcnt(16)
    s_barrier
    v_mov_b32_dpp v116, v28 row_newbcast:4 row_mask:0xf bank_mask:0xf
    v_mov_b32_dpp v117, v29 row_newbcast:4 row_mask:0xf bank_mask:0xf
    v_mov_b32_dpp v118, v30 row_newbcast:4 row_mask:0xf bank_mask:0xf
    v_mov_b32_dpp v119, v31 row_newbcast:4 row_mask:0xf bank_mask:0xf
    v_mov_b32_dpp v120, v28 row_newbcast:5 row_mask:0xf bank_mask:0xf
    v_mov_b32_dpp v121, v29 row_newbcast:5 row_mask:0xf bank_mask:0xf
    v_mov_b32_dpp v122, v30 row_newbcast:5 row_mask:0xf bank_mask:0xf
    v_mov_b32_dpp v123, v31 row_newbcast:5 row_mask:0xf bank_mask:0xf
    v_mov_b32_dpp v124, v28 row_newbcast:6 row_mask:0xf bank_mask:0xf
    v_mov_b32_dpp v125, v29 row_newbcast:6 row_mask:0xf bank_mask:0xf
    v_mov_b32_dpp v126, v30 row_newbcast:6 row_mask:0xf bank_mask:0xf
    v_mov_b32_dpp v127, v31 row_newbcast:6 row_mask:0xf bank_mask:0xf
    v_mov_b32_dpp v128, v28 row_newbcast:7 row_mask:0xf bank_mask:0xf
    v_mov_b32_dpp v129, v29 row_newbcast:7 row_mask:0xf bank_mask:0xf
    v_mov_b32_dpp v130, v30 row_newbcast:7 row_mask:0xf bank_mask:0xf
    v_mov_b32_dpp v131, v31 row_newbcast:7 row_mask:0xf bank_mask:0xf
    s_add_u32 s51, s65, 6
    s_and_b32 s51, s51, 7
    s_mul_i32 s51, s51, 196608
    s_add_u32 s51, s51, s62
    s_add_u32 s95, s51, s40
    s_add_u32 s97, s51, s41
    s_add_u32 s66, s51, s42
    s_add_u32 m0, s64, 49152
    s_add_u32 s50, s95, 0
    buffer_load_dwordx4 v6, s[16:19], s50 offen lds
    s_add_u32 m0, s64, 57344
    s_add_u32 s50, s97, 1024
    buffer_load_dwordx4 v6, s[16:19], s50 offen lds
    s_add_u32 m0, s64, 65536
    s_add_u32 s50, s66, 2048
    buffer_load_dwordx4 v6, s[16:19], s50 offen lds
    s_add_u32 m0, s64, 50176
    s_add_u32 s50, s95, 24576
    buffer_load_dwordx4 v7, s[16:19], s50 offen lds
    s_add_u32 m0, s64, 58368
    s_add_u32 s50, s97, 25600
    buffer_load_dwordx4 v7, s[16:19], s50 offen lds
    s_add_u32 m0, s64, 66560
    s_add_u32 s50, s66, 26624
    buffer_load_dwordx4 v7, s[16:19], s50 offen lds
    s_waitcnt vmcnt(14)
    s_barrier
    v_mov_b32_dpp v132, v28 row_newbcast:8 row_mask:0xf bank_mask:0xf
    v_mov_b32_dpp v133, v29 row_newbcast:8 row_mask:0xf bank_mask:0xf
    v_mov_b32_dpp v134, v30 row_newbcast:8 row_mask:0xf bank_mask:0xf
    v_mov_b32_dpp v135, v31 row_newbcast:8 row_mask:0xf bank_mask:0xf
    v_mov_b32_dpp v136, v28 row_newbcast:9 row_mask:0xf bank_mask:0xf
    v_mov_b32_dpp v137, v29 row_newbcast:9 row_mask:0xf bank_mask:0xf
    v_mov_b32_dpp v138, v30 row_newbcast:9 row_mask:0xf bank_mask:0xf
    v_mov_b32_dpp v139, v31 row_newbcast:9 row_mask:0xf bank_mask:0xf
    v_mov_b32_dpp v140, v28 row_newbcast:10 row_mask:0xf bank_mask:0xf
    v_mov_b32_dpp v141, v29 row_newbcast:10 row_mask:0xf bank_mask:0xf
    v_mov_b32_dpp v142, v30 row_newbcast:10 row_mask:0xf bank_mask:0xf
    v_mov_b32_dpp v143, v31 row_newbcast:10 row_mask:0xf bank_mask:0xf
    v_mov_b32_dpp v144, v28 row_newbcast:11 row_mask:0xf bank_mask:0xf
    v_mov_b32_dpp v145, v29 row_newbcast:11 row_mask:0xf bank_mask:0xf
    v_mov_b32_dpp v146, v30 row_newbcast:11 row_mask:0xf bank_mask:0xf
    v_mov_b32_dpp v147, v31 row_newbcast:11 row_mask:0xf bank_mask:0xf
    s_add_u32 s51, s65, 7
    s_and_b32 s51, s51, 7
    s_mul_i32 s51, s51, 196608
    s_add_u32 s51, s51, s62
    s_add_u32 s95, s51, s40
    s_add_u32 s97, s51, s41
    s_add_u32 s66, s51, s42
    s_add_u32 m0, s64, 73728
    s_add_u32 s50, s95, 0
    buffer_load_dwordx4 v6, s[16:19], s50 offen lds
    s_add_u32 m0, s64, 81920
    s_add_u32 s50, s97, 1024
    buffer_load_dwordx4 v6, s[16:19], s50 offen lds
    s_add_u32 m0, s64, 90112
    s_add_u32 s50, s66, 2048
    buffer_load_dwordx4 v6, s[16:19], s50 offen lds
    s_add_u32 m0, s64, 74752
    s_add_u32 s50, s95, 24576
    buffer_load_dwordx4 v7, s[16:19], s50 offen lds
    s_add_u32 m0, s64, 82944
    s_add_u32 s50, s97, 25600
    buffer_load_dwordx4 v7, s[16:19], s50 offen lds
    s_add_u32 m0, s64, 91136
    s_add_u32 s50, s66, 26624
    buffer_load_dwordx4 v7, s[16:19], s50 offen lds
    s_mov_b64 exec, 0xffffff
    buffer_load_dword v35, v34, s[20:23], 0 offen
    s_mov_b64 exec, -1
    s_waitcnt vmcnt(13)
    s_barrier
    v_mov_b32_dpp v148, v28 row_newbcast:12 row_mask:0xf bank_mask:0xf
    v_mov_b32_dpp v149, v29 row_newbcast:12 row_mask:0xf bank_mask:0xf
    v_mov_b32_dpp v150, v30 row_newbcast:12 row_mask:0xf bank_mask:0xf
    v_mov_b32_dpp v151, v31 row_newbcast:12 row_mask:0xf bank_mask:0xf
    v_mov_b32_dpp v152, v28 row_newbcast:13 row_mask:0xf bank_mask:0xf
    v_mov_b32_dpp v153, v29 row_newbcast:13 row_mask:0xf bank_mask:0xf
    v_mov_b32_dpp v154, v30 row_newbcast:13 row_mask:0xf bank_mask:0xf
    v_mov_b32_dpp v155, v31 row_newbcast:13 row_mask:0xf bank_mask:0xf
    v_mov_b32_dpp v156, v28 row_newbcast:14 row_mask:0xf bank_mask:0xf
    v_mov_b32_dpp v157, v29 row_newbcast:14 row_mask:0xf bank_mask:0xf
    v_mov_b32_dpp v158, v30 row_newbcast:14 row_mask:0xf bank_mask:0xf
    v_mov_b32_dpp v159, v31 row_newbcast:14 row_mask:0xf bank_mask:0xf
    v_mov_b32_dpp v160, v28 row_newbcast:15 row_mask:0xf bank_mask:0xf
    v_mov_b32_dpp v161, v29 row_newbcast:15 row_mask:0xf bank_mask:0xf
    v_mov_b32_dpp v162, v30 row_newbcast:15 row_mask:0xf bank_mask:0xf
    v_mov_b32_dpp v163, v31 row_newbcast:15 row_mask:0xf bank_mask:0xf
    s_waitcnt vmcnt(7)
    s_barrier
    v_and_b32 v8, 15, v1
    v_lshrrev_b32 v9, 4, v1
    v_bfe_u32 v10, v1, 1, 3
    v_xor_b32 v9, v9, v10
    v_lshlrev_b32 v9, 4, v9
    v_lshl_add_u32 v14, v8, 7, v9
    v_add_u32 v14, s63, v14
    v_xor_b32 v15, 64, v14
    s_add_u32 s51, s65, 0
    s_and_b32 s51, s51, 7
    s_mul_i32 s51, s51, 196608
    s_add_u32 s51, s51, s62
    s_add_u32 s95, s51, s43
    s_add_u32 s97, s51, s96
    s_add_u32 s66, s51, s96
    s_add_u32 m0, s64, 0
    s_add_u32 s50, s95, 0
    buffer_load_dwordx4 v6, s[20:23], s50 offen lds
    s_add_u32 m0, s64, 8192
    s_add_u32 s50, s97, 1024
    buffer_load_dwordx4 v6, s[20:23], s50 offen lds
    s_add_u32 m0, s64, 16384
    s_add_u32 s50, s66, 2048
    buffer_load_dwordx4 v6, s[20:23], s50 offen lds
    s_add_u32 m0, s64, 1024
    s_add_u32 s50, s95, 24576
    buffer_load_dwordx4 v7, s[20:23], s50 offen lds
    s_add_u32 m0, s64, 9216
    s_add_u32 s50, s97, 25600
    buffer_load_dwordx4 v7, s[20:23], s50 offen lds
    s_add_u32 m0, s64, 17408
    s_add_u32 s50, s66, 26624
    buffer_load_dwordx4 v7, s[20:23], s50 offen lds
    s_waitcnt vmcnt(7)
    s_barrier
    s_add_u32 s51, s65, 1
    s_and_b32 s51, s51, 7
    s_mul_i32 s51, s51, 196608
    s_add_u32 s51, s51, s62
    s_add_u32 s95, s51, s43
    s_add_u32 s97, s51, s96
    s_add_u32 s66, s51, s96
    s_add_u32 m0, s64, 24576
    s_add_u32 s50, s95, 0
    buffer_load_dwordx4 v6, s[20:23], s50 offen lds
    s_add_u32 m0, s64, 32768
    s_add_u32 s50, s97, 1024
    buffer_load_dwordx4 v6, s[20:23], s50 offen lds
    s_add_u32 m0, s64, 40960
    s_add_u32 s50, s66, 2048
    buffer_load_dwordx4 v6, s[20:23], s50 offen lds
    s_add_u32 m0, s64, 25600
    s_add_u32 s50, s95, 24576
    buffer_load_dwordx4 v7, s[20:23], s50 offen lds
    s_add_u32 m0, s64, 33792
    s_add_u32 s50, s97, 25600
    buffer_load_dwordx4 v7, s[20:23], s50 offen lds
    s_add_u32 m0, s64, 41984
    s_add_u32 s50, s66, 26624
    buffer_load_dwordx4 v7, s[20:23], s50 offen lds
    ds_read_b128 v[164:167], v14 offset:0
    ds_read_b128 v[168:171], v15 offset:0
    ds_read_b128 v[172:175], v14 offset:8192
    ds_read_b128 v[176:179], v15 offset:8192
    ds_read_b128 v[180:183], v14 offset:16384
    ds_read_b128 v[184:187], v15 offset:16384
    ds_read_b128 v[188:191], v14 offset:24576
    ds_read_b128 v[192:195], v15 offset:24576
    ds_read_b128 v[196:199], v14 offset:32768
    ds_read_b128 v[200:203], v15 offset:32768
    ds_read_b128 v[204:207], v14 offset:40960
    ds_read_b128 v[208:211], v15 offset:40960
    ds_read_b128 v[212:215], v14 offset:49152
    ds_read_b128 v[216:219], v15 offset:49152
    ds_read_b128 v[220:223], v14 offset:57344
    ds_read_b128 v[16:19], v15 offset:57344
    s_waitcnt lgkmcnt(0)
    v_mfma_f32_16x16x32_bf16 v[20:23], v[100:103], v[164:167], 0
    v_mfma_f32_16x16x32_bf16 v[24:27], v[104:107], v[168:171], 0
    v_mfma_f32_16x16x32_bf16 v[20:23], v[108:111], v[172:175], v[20:23]
    v_mfma_f32_16x16x32_bf16 v[24:27], v[112:115], v[176:179], v[24:27]
    v_mfma_f32_16x16x32_bf16 v[20:23], v[116:119], v[180:183], v[20:23]
    v_mfma_f32_16x16x32_bf16 v[24:27], v[120:123], v[184:187], v[24:27]
    v_mfma_f32_16x16x32_bf16 v[20:23], v[124:127], v[188:191], v[20:23]
    v_mfma_f32_16x16x32_bf16 v[24:27], v[128:131], v[192:195], v[24:27]
    v_mfma_f32_16x16x32_bf16 v[20:23], v[132:135], v[196:199], v[20:23]
    v_mfma_f32_16x16x32_bf16 v[24:27], v[136:139], v[200:203], v[24:27]
    v_mfma_f32_16x16x32_bf16 v[20:23], v[140:143], v[204:207], v[20:23]
    v_mfma_f32_16x16x32_bf16 v[24:27], v[144:147], v[208:211], v[24:27]
    v_mfma_f32_16x16x32_bf16 v[20:23], v[148:151], v[212:215], v[20:23]
    v_mfma_f32_16x16x32_bf16 v[24:27], v[152:155], v[216:219], v[24:27]
    v_mfma_f32_16x16x32_bf16 v[20:23], v[156:159], v[220:223], v[20:23]
    v_mfma_f32_16x16x32_bf16 v[24:27], v[160:163], v[16:19], v[24:27]
    s_waitcnt vmcnt(6)
    s_barrier
    s_add_u32 s51, s65, 2
    s_and_b32 s51, s51, 7
    s_mul_i32 s51, s51, 196608
    s_add_u32 s51, s51, s62
    s_add_u32 s95, s51, s43
    s_add_u32 s97, s51, s96
    s_add_u32 s66, s51, s96
    s_add_u32 m0, s64, 49152
    s_add_u32 s50, s95, 0
    buffer_load_dwordx4 v6, s[20:23], s50 offen lds
    s_add_u32 m0, s64, 57344
    s_add_u32 s50, s97, 1024
    buffer_load_dwordx4 v6, s[20:23], s50 offen lds
    s_add_u32 m0, s64, 65536
    s_add_u32 s50, s66, 2048
    buffer_load_dwordx4 v6, s[20:23], s50 offen lds
    s_add_u32 m0, s64, 50176
    s_add_u32 s50, s95, 24576
    buffer_load_dwordx4 v7, s[20:23], s50 offen lds
    s_add_u32 m0, s64, 58368
    s_add_u32 s50, s97, 25600
    buffer_load_dwordx4 v7, s[20:23], s50 offen lds
    s_add_u32 m0, s64, 66560
    s_add_u32 s50, s66, 26624
    buffer_load_dwordx4 v7, s[20:23], s50 offen lds
    s_waitcnt vmcnt(6)
    s_barrier
    s_add_u32 s51, s65, 3
    s_and_b32 s51, s51, 7
    s_mul_i32 s51, s51, 196608
    s_add_u32 s51, s51, s62
    s_add_u32 s95, s51, s43
    s_add_u32 s97, s51, s96
    s_add_u32 s66, s51, s96
    s_add_u32 m0, s64, 73728
    s_add_u32 s50, s95, 0
    buffer_load_dwordx4 v6, s[20:23], s50 offen lds
    s_add_u32 m0, s64, 81920
    s_add_u32 s50, s97, 1024
    buffer_load_dwordx4 v6, s[20:23], s50 offen lds
    s_add_u32 m0, s64, 90112
    s_add_u32 s50, s66, 2048
    buffer_load_dwordx4 v6, s[20:23], s50 offen lds
    s_add_u32 m0, s64, 74752
    s_add_u32 s50, s95, 24576
    buffer_load_dwordx4 v7, s[20:23], s50 offen lds
    s_add_u32 m0, s64, 82944
    s_add_u32 s50, s97, 25600
    buffer_load_dwordx4 v7, s[20:23], s50 offen lds
    s_add_u32 m0, s64, 91136
    s_add_u32 s50, s66, 26624
    buffer_load_dwordx4 v7, s[20:23], s50 offen lds
    s_lshl_b32 s94, s46, 14
    s_lshl_b32 s50, s45, 9
    s_add_u32 s94, s94, s50
    s_lshl_b32 s50, s60, 7
    s_add_u32 s94, s94, s50
    s_add_u32 s94, s94, 14680064
    v_lshlrev_b32 v11, 3, v1
    v_add_f32 v14, v20, v24
    v_cvt_pk_bf16_f32 v14, v14, v14
    v_lshlrev_b32 v14, 16, v14
    v_mul_f32 v14, 0xbfb8aa3b, v14
    v_exp_f32 v14, v14
    s_nop 0
    v_add_f32 v14, 1.0, v14
    v_rcp_f32 v14, v14
    s_nop 0
    v_cvt_pk_bf16_f32 v14, v14, v14
    v_lshlrev_b32 v14, 16, v14
    v_sub_f32 v15, 1.0, v14
    v_cvt_pk_bf16_f32 v15, v15, v15
    v_lshlrev_b32 v15, 16, v15
    s_mov_b64 exec, 0xffff
    buffer_store_dwordx2 v[14:15], v11, s[8:11], s94 offen sc1
    s_mov_b64 exec, -1
    s_waitcnt vmcnt(7)
    s_barrier
    s_add_u32 s51, s65, 4
    s_and_b32 s51, s51, 7
    s_mul_i32 s51, s51, 196608
    s_add_u32 s51, s51, s62
    s_add_u32 s95, s51, s43
    s_add_u32 s97, s51, s96
    s_add_u32 s66, s51, s96
    s_add_u32 m0, s64, 0
    s_add_u32 s50, s95, 0
    buffer_load_dwordx4 v6, s[20:23], s50 offen lds
    s_add_u32 m0, s64, 8192
    s_add_u32 s50, s97, 1024
    buffer_load_dwordx4 v6, s[20:23], s50 offen lds
    s_add_u32 m0, s64, 16384
    s_add_u32 s50, s66, 2048
    buffer_load_dwordx4 v6, s[20:23], s50 offen lds
    s_add_u32 m0, s64, 1024
    s_add_u32 s50, s95, 24576
    buffer_load_dwordx4 v7, s[20:23], s50 offen lds
    s_add_u32 m0, s64, 9216
    s_add_u32 s50, s97, 25600
    buffer_load_dwordx4 v7, s[20:23], s50 offen lds
    s_add_u32 m0, s64, 17408
    s_add_u32 s50, s66, 26624
    buffer_load_dwordx4 v7, s[20:23], s50 offen lds
    s_waitcnt vmcnt(7)
    s_barrier
    s_add_u32 s51, s65, 5
    s_and_b32 s51, s51, 7
    s_mul_i32 s51, s51, 196608
    s_add_u32 s51, s51, s62
    s_add_u32 s95, s51, s43
    s_add_u32 s97, s51, s96
    s_add_u32 s66, s51, s96
    s_add_u32 m0, s64, 24576
    s_add_u32 s50, s95, 0
    buffer_load_dwordx4 v6, s[20:23], s50 offen lds
    s_add_u32 m0, s64, 32768
    s_add_u32 s50, s97, 1024
    buffer_load_dwordx4 v6, s[20:23], s50 offen lds
    s_add_u32 m0, s64, 40960
    s_add_u32 s50, s66, 2048
    buffer_load_dwordx4 v6, s[20:23], s50 offen lds
    s_add_u32 m0, s64, 25600
    s_add_u32 s50, s95, 24576
    buffer_load_dwordx4 v7, s[20:23], s50 offen lds
    s_add_u32 m0, s64, 33792
    s_add_u32 s50, s97, 25600
    buffer_load_dwordx4 v7, s[20:23], s50 offen lds
    s_add_u32 m0, s64, 41984
    s_add_u32 s50, s66, 26624
    buffer_load_dwordx4 v7, s[20:23], s50 offen lds
    s_waitcnt vmcnt(6)
    s_barrier
    s_add_u32 s51, s65, 6
    s_and_b32 s51, s51, 7
    s_mul_i32 s51, s51, 196608
    s_add_u32 s51, s51, s62
    s_add_u32 s95, s51, s43
    s_add_u32 s97, s51, s96
    s_add_u32 s66, s51, s96
    s_add_u32 m0, s64, 49152
    s_add_u32 s50, s95, 0
    buffer_load_dwordx4 v6, s[20:23], s50 offen lds
    s_add_u32 m0, s64, 57344
    s_add_u32 s50, s97, 1024
    buffer_load_dwordx4 v6, s[20:23], s50 offen lds
    s_add_u32 m0, s64, 65536
    s_add_u32 s50, s66, 2048
    buffer_load_dwordx4 v6, s[20:23], s50 offen lds
    s_add_u32 m0, s64, 50176
    s_add_u32 s50, s95, 24576
    buffer_load_dwordx4 v7, s[20:23], s50 offen lds
    s_add_u32 m0, s64, 58368
    s_add_u32 s50, s97, 25600
    buffer_load_dwordx4 v7, s[20:23], s50 offen lds
    s_add_u32 m0, s64, 66560
    s_add_u32 s50, s66, 26624
    buffer_load_dwordx4 v7, s[20:23], s50 offen lds
    s_waitcnt vmcnt(6)
    s_barrier
    s_add_u32 s51, s65, 7
    s_and_b32 s51, s51, 7
    s_mul_i32 s51, s51, 196608
    s_add_u32 s51, s51, s62
    s_add_u32 s95, s51, s43
    s_add_u32 s97, s51, s96
    s_add_u32 s66, s51, s96
    s_add_u32 m0, s64, 73728
    s_add_u32 s50, s95, 0
    buffer_load_dwordx4 v6, s[20:23], s50 offen lds
    s_add_u32 m0, s64, 81920
    s_add_u32 s50, s97, 1024
    buffer_load_dwordx4 v6, s[20:23], s50 offen lds
    s_add_u32 m0, s64, 90112
    s_add_u32 s50, s66, 2048
    buffer_load_dwordx4 v6, s[20:23], s50 offen lds
    s_add_u32 m0, s64, 74752
    s_add_u32 s50, s95, 24576
    buffer_load_dwordx4 v7, s[20:23], s50 offen lds
    s_add_u32 m0, s64, 82944
    s_add_u32 s50, s97, 25600
    buffer_load_dwordx4 v7, s[20:23], s50 offen lds
    s_add_u32 m0, s64, 91136
    s_add_u32 s50, s66, 26624
    buffer_load_dwordx4 v7, s[20:23], s50 offen lds
    s_add_u32 s49, s49, 2654435769
    v_mov_b32 v251, s49
    s_waitcnt vmcnt(6)
    s_barrier
    s_and_b32 s67, s47, 3
    s_lshl_b32 s67, s67, 9
    s_add_u32 s67, s67, 14942208
    s_lshr_b32 s50, s47, 2
    s_sub_u32 s50, s50, 0
    s_and_b32 s50, s50, 7
    s_lshl_b32 s50, s50, 5
    s_add_u32 s50, s50, s48
    s_lshl_b32 s50, s50, 6
    v_and_b32 v8, 3, v1
    v_lshl_add_u32 v8, v8, 4, s50
    s_lshl_b32 s50, s48, 13
    s_add_u32 s62, s59, s50
    s_add_u32 s62, s62, s64
    s_lshl_b32 s63, s60, 12
    s_and_b32 s50, s60, 1
    s_lshl_b32 s50, s50, 15
    s_add_u32 s61, s59, s50
    s_lshr_b32 s50, s60, 1
    s_lshl_b32 s50, s50, 21
    s_add_u32 s61, s61, s50
    buffer_load_dword v9, v229, s[8:11], s67 offen sc1
    buffer_load_dword v10, v8, s[8:11], s67 offen sc1
    s_waitcnt vmcnt(2)
    s_barrier
    s_mov_b32 s50, 0
    s_branch L_f1_chk
L_f1_spin:
    buffer_load_dword v9, v229, s[8:11], s67 offen sc1
    buffer_load_dword v10, v8, s[8:11], s67 offen sc1
L_f1_chk:
    s_add_u32 s50, s50, 1
    s_waitcnt vmcnt(0)
    v_cmp_ne_u32 vcc, s49, v9
    v_cmp_ne_u32 s[6:7], s49, v10
    s_cmp_gt_u32 s50, 60000
    s_cbranch_scc1 L_f1_ok
    s_or_b64 vcc, vcc, s[6:7]
    s_cbranch_scc1 L_f1_spin
L_f1_ok:
    s_add_u32 m0, s64, 65536
    s_add_u32 s50, s62, 0
    buffer_load_dwordx4 v2, s[8:11], s50 offen sc1 lds
    s_add_u32 m0, s64, 66560
    s_add_u32 s50, s62, 1024
    buffer_load_dwordx4 v2, s[8:11], s50 offen sc1 lds
    s_add_u32 m0, s63, 0
    s_add_u32 s51, s61, 2097152
    buffer_load_dwordx4 v2, s[8:11], s51 offen offset:0 sc1 lds
    buffer_load_dwordx4 v2, s[8:11], s51 offen offset:1024 sc1 lds
    buffer_load_dwordx4 v2, s[8:11], s51 offen offset:2048 sc1 lds
    buffer_load_dwordx4 v2, s[8:11], s51 offen offset:3072 sc1 lds
    s_add_u32 m0, s63, 16384
    s_add_u32 s51, s61, 2101248
    buffer_load_dwordx4 v2, s[8:11], s51 offen offset:0 sc1 lds
    buffer_load_dwordx4 v2, s[8:11], s51 offen offset:1024 sc1 lds
    buffer_load_dwordx4 v2, s[8:11], s51 offen offset:2048 sc1 lds
    buffer_load_dwordx4 v2, s[8:11], s51 offen offset:3072 sc1 lds
    s_waitcnt vmcnt(4)
    s_branch L_attn
.p2align 5
L_compute:
    s_getpc_b64 s[6:7]
L_pc:
    s_sub_u32 s6, s6, L_pc-gated_mix__mha_block__linear_attn_block__prompt_kernel
    s_subb_u32 s7, s7, 0
    s_lshr_b32 s5, s2, 3
    s_lshl_b32 s5, s5, 10
    v_lshl_add_u32 v14, v1, 7, s5
    v_mov_b32 v13, s7
    v_add_co_u32 v12, vcc, s6, v14
    s_mov_b32 s4, L_end-gated_mix__mha_block__linear_attn_block__prompt_kernel
    s_cmp_lg_u32 s44, 0
    v_addc_co_u32 v13, vcc, 0, v13, vcc
    v_cmp_gt_u32 vcc, s4, v14
    s_cbranch_scc1 L_nopfc
    s_and_b64 exec, vcc, 0xff
    s_cbranch_execz L_nopfc1
    global_load_dword v15, v[12:13], off
L_nopfc1:
    s_mov_b64 exec, -1
L_nopfc:
    s_mov_b32 s10, 0x1000000
    s_mov_b32 s11, 0x20000
    s_mov_b32 s22, 0x180000
    s_mov_b32 s23, 0x20000
    s_mov_b32 s26, 0x400
    s_mov_b32 s27, 0x20000
    s_mov_b32 s30, 0x80000
    s_mov_b32 s31, 0x20000
    s_mov_b32 s34, 0x80000
    s_mov_b32 s35, 0x20000
    s_mov_b32 s38, 0x200000
    s_mov_b32 s39, 0x20000
    s_waitcnt lgkmcnt(0)
    s_add_u32 s6, s8, 14909440
    s_addc_u32 s7, s9, 0
    s_load_dword s49, s[6:7], 0
    v_and_b32 v8, 15, v1
    v_lshrrev_b32 v9, 4, v1
    v_bfe_u32 v10, v1, 1, 3
    v_xor_b32 v10, v9, v10
    v_lshlrev_b32 v10, 4, v10
    v_lshl_add_u32 v4, v8, 7, v10
    v_add_u32 v4, 98304, v4
    v_xor_b32 v5, 64, v4
    v_lshrrev_b32 v10, 2, v8
    v_lshl_add_u32 v10, v9, 3, v10
    v_lshlrev_b32 v6, 7, v10
    v_bfe_u32 v10, v1, 3, 2
    v_xor_b32 v10, s44, v10
    v_lshl_add_u32 v6, v10, 5, v6
    v_and_b32 v10, 3, v1
    v_lshl_add_u32 v6, v10, 3, v6
    v_add_u32 v7, 49152, v6
    v_and_b32 v11, 12, v1
    v_lshlrev_b32 v11, 1, v11
    v_and_b32 v10, 0x23, v1
    v_or_b32 v11, v11, v10
    v_bfe_u32 v10, v1, 4, 1
    v_lshl_add_u32 v11, v10, 2, v11
    v_lshlrev_b32 v11, 4, v11
    v_and_b32 v10, 48, v1
    v_lshl_add_u32 v8, v8, 6, v10
    s_lshl_b32 s50, s45, 11
    s_lshl_b32 s4, s44, 16
    s_add_u32 s50, s50, s4
    s_add_u32 s4, s46, 0
    s_and_b32 s4, s4, 7
    s_lshl_b32 s4, s4, 18
    s_add_u32 s4, s4, s50
    s_add_u32 s61, s4, 0
    s_add_u32 s4, s46, 2
    s_and_b32 s4, s4, 7
    s_lshl_b32 s4, s4, 18
    s_add_u32 s4, s4, s50
    s_add_u32 s62, s4, 2097152
    s_add_u32 s4, s46, 4
    s_and_b32 s4, s4, 7
    s_lshl_b32 s4, s4, 18
    s_add_u32 s4, s4, s50
    s_add_u32 s63, s4, 4194304
    s_add_u32 s4, s46, 6
    s_and_b32 s4, s4, 7
    s_lshl_b32 s4, s4, 18
    s_add_u32 s4, s4, s50
    s_add_u32 s64, s4, 6291456
    s_add_u32 s4, s46, 1
    s_and_b32 s4, s4, 7
    s_lshl_b32 s4, s4, 2
    s_add_u32 s4, s4, s44
    s_mul_i32 s65, s4, 34816
    s_mul_i32 s50, s45, 1088
    s_add_u32 s65, s65, s50
    s_add_u32 s65, s65, 12582912
    s_lshl_b32 s60, s46, 2
    s_add_u32 s60, s60, s44
    s_lshl_b32 s60, s60, 5
    s_add_u32 s60, s60, s45
    s_lshl_b32 s60, s60, 4
    s_add_u32 s60, s60, 14942208
    s_mov_b32 s66, 0x3eb8aa3b
    s_mov_b32 s67, 0x3eb8aa3b
    s_and_b32 s4, s2, 7
    s_lshr_b32 s5, s2, 3
    s_lshl_b32 s47, s4, 2
    s_and_b32 s6, s5, 3
    s_add_u32 s47, s47, s6
    s_lshr_b32 s48, s5, 2
    s_lshl_b32 s59, s47, 16
    s_lshl_b32 s68, s4, 2
    s_lshr_b32 s6, s2, 6
    s_add_u32 s68, s68, s6
    s_and_b32 s69, s5, 7
    s_and_b32 s71, s44, 1
    s_lshr_b32 s70, s44, 1
    s_mov_b32 s52, 0x3fb8aa3b
    s_mov_b32 s53, 0x3fb8aa3b
    s_mov_b32 s54, 0x358637bd
    s_mov_b32 s55, 0x358637bd
    s_mov_b32 s56, 0xffff
    s_mov_b32 s57, 0xffff
    s_lshr_b32 s4, s44, 2
    s_and_b32 s5, s44, 3
    s_lshl_b32 s5, s5, 1
    s_add_u32 s5, s5, s4
    s_lshl_b32 s58, s48, 3
    s_add_u32 s58, s58, s5
    s_lshl_b32 s5, s5, 10
    s_add_u32 s5, s5, 65536
    v_add_u32 v228, s5, v2
    s_lshl_b32 s4, s4, 12
    v_add_u32 v226, s4, v2
    v_and_b32 v246, 15, v1
    v_lshrrev_b32 v247, 5, v1
    v_lshl_add_u32 v246, v247, 4, v246
    s_add_u32 s4, s4, 8192
    v_lshl_add_u32 v227, v246, 4, s4
    v_mov_b32 v3, 0xdddd
    v_mov_b32 v252, 0
    v_lshlrev_b32 v253, 10, v1
    v_and_b32 v246, 31, v1
    s_lshr_b32 s4, s47, 2
    s_sub_u32 s5, s4, 2
    s_and_b32 s5, s5, 7
    s_lshl_b32 s5, s5, 11
    s_sub_u32 s6, s4, 4
    s_and_b32 s6, s6, 7
    s_lshl_b32 s6, s6, 11
    v_mov_b32 v248, s5
    v_mov_b32 v249, s6
    v_cmp_gt_u32 vcc, 32, v1
    s_sub_u32 s5, s4, 1
    s_and_b32 s5, s5, 7
    v_cndmask_b32 v248, v249, v248, vcc
    v_lshl_add_u32 v229, v246, 4, v248
    s_lshl_b32 s5, s5, 9
    v_lshl_add_u32 v248, v246, 4, s5
    s_sub_u32 s6, s4, 6
    s_and_b32 s6, s6, 7
    s_lshl_b32 s78, s6, 14
    s_lshl_b32 s6, s6, 5
    s_lshr_b32 s5, s58, 1
    s_add_u32 s6, s6, s5
    s_lshl_b32 s6, s6, 4
    v_mov_b32 v249, s6
    v_cndmask_b32 v230, v249, v248, vcc
    v_lshlrev_b32 v233, 3, v246
    v_lshlrev_b32 v248, 5, v247
    v_lshl_add_u32 v232, v246, 6, v248
    v_add_u32 v248, 0x400, v248
    v_cmp_gt_u32 vcc, 16, v246
    s_lshl_b32 s4, s44, 11
    s_add_u32 s4, s4, 131072
    v_cndmask_b32 v232, v248, v232, vcc
    v_add_u32 v234, s4, v2
    v_add_u32 v235, 131072, v2
    s_lshl_b32 s4, s44, 8
    s_add_u32 s4, s4, 114688
    v_lshl_add_u32 v239, v1, 2, s4
    s_xor_b32 s4, s4, 0x400
    v_lshl_add_u32 v241, v246, 2, s4
    v_xor_b32 v240, 0x2000, v234
    v_lshrrev_b32 v248, 3, v1
    v_and_b32 v249, 7, v1
    v_lshlrev_b32 v231, 4, v249
    v_bfe_u32 v236, v1, 4, 1
    v_lshlrev_b32 v236, 2, v236
    v_xor_b32 v236, v249, v236
    v_lshlrev_b32 v236, 4, v236
    v_lshl_add_u32 v236, v248, 10, v236
    v_lshlrev_b32 v242, 4, v249
    v_lshl_add_u32 v242, v246, 8, v242
    v_bfe_u32 v249, v1, 1, 1
    v_xor_b32 v249, v249, v247
    v_lshl_add_u32 v242, v249, 7, v242
    s_lshl_b32 s4, s70, 14
    s_lshl_b32 s5, s71, 13
    s_add_u32 s5, s5, s4
    v_add_u32 v242, s5, v242
    v_bfe_u32 v248, v1, 2, 2
    v_lshl_add_u32 v248, v247, 2, v248
    v_lshlrev_b32 v237, 7, v248
    v_bfe_u32 v248, v1, 3, 1
    v_lshl_add_u32 v237, v248, 6, v237
    v_bfe_u32 v248, v1, 4, 1
    v_lshl_add_u32 v237, v248, 5, v237
    v_and_b32 v248, 3, v1
    v_lshl_add_u32 v237, v248, 3, v237
    v_add_u32 v237, s4, v237
    v_xor_b32 v238, 64, v237
    v_lshrrev_b32 v246, 3, v0
    v_and_b32 v247, 7, v0
    v_and_b32 v248, 7, v246
    v_xor_b32 v248, v248, v247
    v_lshlrev_b32 v243, 4, v248
    v_lshl_add_u32 v243, v246, 8, v243
    v_bfe_u32 v248, v246, 1, 1
    v_lshl_add_u32 v243, v248, 7, v243
    v_xor_b32 v244, 0x80, v243
    v_lshlrev_b32 v245, 4, v247
    v_lshl_add_u32 v245, v246, 10, v245
    s_lshl_b32 s5, s71, 11
    s_lshl_b32 s73, s70, 12
    s_add_u32 s73, s73, s5
    s_add_u32 s72, s59, s5
    s_and_b32 s5, s70, 1
    s_lshl_b32 s5, s5, 15
    s_add_u32 s72, s72, s5
    s_lshr_b32 s5, s70, 1
    s_lshl_b32 s5, s5, 21
    s_add_u32 s72, s72, s5
    s_add_u32 s72, s72, 2097152
    s_lshl_b32 s5, s46, 5
    s_add_u32 s5, s5, s45
    s_lshl_b32 s5, s5, 4
    s_add_u32 s74, s5, 15073280
    s_mov_b32 s75, 15073280
    s_lshl_b32 s5, s58, 8
    s_add_u32 s78, s78, s5
    s_add_u32 s78, s78, 14680064
    s_mul_i32 s4, s47, 34816
    s_mul_i32 s5, s44, 4352
    s_add_u32 s4, s4, s5
    s_add_u32 s76, s4, 12582912
    s_lshl_b32 s4, s58, 10
    s_add_u32 s4, s4, s59
    s_add_u32 s77, s4, 6291456
    s_lshl_b32 s4, s58, 2
    s_add_u32 s4, s4, s47
    s_and_b32 s4, s4, 31
    s_lshl_b32 s4, s4, 10
    s_lshl_b32 s5, s58, 15
    s_add_u32 s4, s4, s5
    s_add_u32 s79, s4, 10485760
    s_add_u32 s80, s4, 8388608
    s_lshl_b32 s4, s58, 5
    s_add_u32 s4, s4, s47
    s_lshl_b32 s4, s4, 4
    s_add_u32 s81, s4, 15204352
    s_lshl_b32 s6, s69, 7
    s_lshr_b32 s4, s2, 6
    s_lshl_b32 s4, s4, 17
    s_lshl_b32 s5, s44, 14
    s_add_u32 s4, s4, s5
    s_add_u32 s82, s4, s6
    s_lshl_b32 s84, s44, 10
    s_lshl_b32 s4, s44, 13
    s_add_u32 s83, s4, s6
    s_lshl_b32 s4, s68, 16
    s_add_u32 s90, s4, s6
    s_lshl_b32 s6, s68, 1
    s_add_u32 s6, s6, s71
    s_lshl_b32 s4, s6, 2
    s_add_u32 s4, s4, s70
    s_lshl_b32 s4, s4, 7
    s_add_u32 s85, s4, 15204352
    s_lshl_b32 s4, s70, 1
    s_add_u32 s4, s4, s6
    s_lshl_b32 s6, s6, 15
    s_and_b32 s5, s4, 7
    s_lshl_b32 s5, s5, 12
    s_add_u32 s5, s5, s6
    s_add_u32 s86, s5, 10485760
    s_add_u32 s88, s5, 8388608
    s_add_u32 s4, s4, 1
    s_and_b32 s5, s4, 7
    s_lshl_b32 s5, s5, 12
    s_add_u32 s5, s5, s6
    s_add_u32 s87, s5, 10485760
    s_add_u32 s89, s5, 8388608
    v_mov_b32 v84, 0
    v_mov_b32 v85, 0
    v_mov_b32 v86, 0
    v_mov_b32 v87, 0
    v_mov_b32 v88, 0
    v_mov_b32 v89, 0
    v_mov_b32 v90, 0
    v_mov_b32 v91, 0
    v_mov_b32 v92, 0
    v_mov_b32 v93, 0
    v_mov_b32 v94, 0
    v_mov_b32 v95, 0
    v_mov_b32 v96, 0
    v_mov_b32 v97, 0
    v_mov_b32 v98, 0
    v_mov_b32 v99, 0
    s_mov_b32 exec_lo, 0x00010000
    s_mov_b32 exec_hi, 0x00010000
    v_mov_b32 v84, 0x3f803f80
    v_mov_b32 v85, 0x3f803f80
    v_mov_b32 v86, 0x3f803f80
    v_mov_b32 v87, 0x3f803f80
    v_mov_b32 v88, 0x3f803f80
    v_mov_b32 v89, 0x3f803f80
    v_mov_b32 v90, 0x3f803f80
    v_mov_b32 v91, 0x3f803f80
    v_mov_b32 v92, 0x3f803f80
    v_mov_b32 v93, 0x3f803f80
    v_mov_b32 v94, 0x3f803f80
    v_mov_b32 v95, 0x3f803f80
    v_mov_b32 v96, 0x3f803f80
    v_mov_b32 v97, 0x3f803f80
    v_mov_b32 v98, 0x3f803f80
    v_mov_b32 v99, 0x3f803f80
    s_mov_b64 exec, -1
    v_mov_b32 v44, 0
    v_mov_b32 v45, 0
    v_mov_b32 v46, 0
    v_mov_b32 v47, 0
    v_mov_b32 v48, 0
    v_mov_b32 v49, 0
    v_mov_b32 v50, 0
    v_mov_b32 v51, 0
    v_mov_b32 v52, 0
    v_mov_b32 v53, 0
    v_mov_b32 v54, 0
    v_mov_b32 v55, 0
    v_mov_b32 v56, 0
    v_mov_b32 v57, 0
    v_mov_b32 v58, 0
    v_mov_b32 v59, 0
    v_mov_b32 v60, 0
    v_mov_b32 v61, 0
    v_mov_b32 v62, 0
    v_mov_b32 v63, 0
    v_mov_b32 v64, 0
    v_mov_b32 v65, 0
    v_mov_b32 v66, 0
    v_mov_b32 v67, 0
    v_mov_b32 v68, 0
    v_mov_b32 v69, 0
    v_mov_b32 v70, 0
    v_mov_b32 v71, 0
    v_mov_b32 v72, 0
    v_mov_b32 v73, 0
    v_mov_b32 v74, 0
    v_mov_b32 v75, 0
    v_mov_b32 v24, 0x3f803f80
    v_mov_b32 v25, 0x3f803f80
    v_mov_b32 v26, 0x3f803f80
    v_mov_b32 v27, 0x3f803f80
    s_barrier
    ds_read_b128 v[196:199], v4 offset:0
    ds_read_b64_tr_b16 v[212:213], v6 offset:0
    ds_read_b64_tr_b16 v[214:215], v6 offset:512
    ds_read_b64_tr_b16 v[216:217], v6 offset:8192
    ds_read_b64_tr_b16 v[218:219], v6 offset:8704
    ds_read_b64_tr_b16 v[220:221], v6 offset:16384
    ds_read_b64_tr_b16 v[222:223], v6 offset:16896
    ds_read_b128 v[200:203], v4 offset:2048
    ds_read_b128 v[204:207], v4 offset:4096
    ds_read_b128 v[208:211], v4 offset:6144
    s_waitcnt lgkmcnt(0)
    v_mfma_f32_16x16x32_bf16 v[100:103], v[212:215], v[196:199], 0
    ds_read_b128 v[28:31], v5 offset:0
    v_mfma_f32_16x16x32_bf16 v[116:119], v[216:219], v[196:199], 0
    ds_read_b64_tr_b16 v[76:77], v6 offset:4096
    v_mfma_f32_16x16x32_bf16 v[132:135], v[196:199], v[220:223], 0
    ds_read_b64_tr_b16 v[78:79], v6 offset:4608
    v_mfma_f32_16x16x32_bf16 v[104:107], v[212:215], v[200:203], 0
    ds_read_b64_tr_b16 v[80:81], v6 offset:12288
    v_mfma_f32_16x16x32_bf16 v[120:123], v[216:219], v[200:203], 0
    ds_read_b64_tr_b16 v[82:83], v6 offset:12800
    v_mfma_f32_16x16x32_bf16 v[136:139], v[200:203], v[220:223], 0
    ds_read_b64_tr_b16 v[246:247], v6 offset:20480
    v_mfma_f32_16x16x32_bf16 v[108:111], v[212:215], v[204:207], 0
    ds_read_b64_tr_b16 v[248:249], v6 offset:20992
    v_mfma_f32_16x16x32_bf16 v[124:127], v[216:219], v[204:207], 0
    ds_read_b128 v[32:35], v5 offset:2048
    v_mfma_f32_16x16x32_bf16 v[140:143], v[204:207], v[220:223], 0
    ds_read_b128 v[36:39], v5 offset:4096
    v_mfma_f32_16x16x32_bf16 v[112:115], v[212:215], v[208:211], 0
    ds_read_b128 v[40:43], v5 offset:6144
    v_mfma_f32_16x16x32_bf16 v[128:131], v[216:219], v[208:211], 0
    v_mfma_f32_16x16x32_bf16 v[144:147], v[208:211], v[220:223], 0
    s_waitcnt lgkmcnt(3)
    v_mfma_f32_16x16x32_bf16 v[100:103], v[76:79], v[28:31], v[100:103]
    v_mfma_f32_16x16x32_bf16 v[116:119], v[80:83], v[28:31], v[116:119]
    s_waitcnt lgkmcnt(0)
    s_barrier
    v_mfma_f32_16x16x32_bf16 v[132:135], v[28:31], v[246:249], v[132:135]
    ds_read_b128 v[196:199], v4 offset:8192
    v_mfma_f32_16x16x32_bf16 v[104:107], v[76:79], v[32:35], v[104:107]
    ds_read_b64_tr_b16 v[212:213], v6 offset:24576
    v_mfma_f32_16x16x32_bf16 v[120:123], v[80:83], v[32:35], v[120:123]
    ds_read_b64_tr_b16 v[214:215], v6 offset:25088
    v_mfma_f32_16x16x32_bf16 v[136:139], v[32:35], v[246:249], v[136:139]
    ds_read_b64_tr_b16 v[216:217], v6 offset:32768
    v_mfma_f32_16x16x32_bf16 v[108:111], v[76:79], v[36:39], v[108:111]
    ds_read_b64_tr_b16 v[218:219], v6 offset:33280
    v_mfma_f32_16x16x32_bf16 v[124:127], v[80:83], v[36:39], v[124:127]
    ds_read_b64_tr_b16 v[220:221], v6 offset:40960
    v_mfma_f32_16x16x32_bf16 v[140:143], v[36:39], v[246:249], v[140:143]
    ds_read_b64_tr_b16 v[222:223], v6 offset:41472
    v_mfma_f32_16x16x32_bf16 v[112:115], v[76:79], v[40:43], v[112:115]
    ds_read_b128 v[200:203], v4 offset:10240
    v_mfma_f32_16x16x32_bf16 v[128:131], v[80:83], v[40:43], v[128:131]
    ds_read_b128 v[204:207], v4 offset:12288
    v_mfma_f32_16x16x32_bf16 v[144:147], v[40:43], v[246:249], v[144:147]
    ds_read_b128 v[208:211], v4 offset:14336
    s_add_u32 s49, s49, 2654435769
    v_mov_b32 v251, s49
    s_waitcnt lgkmcnt(3)
    v_mfma_f32_16x16x32_bf16 v[100:103], v[212:215], v[196:199], v[100:103]
    ds_read_b128 v[28:31], v5 offset:8192
    v_mfma_f32_16x16x32_bf16 v[116:119], v[216:219], v[196:199], v[116:119]
    ds_read_b64_tr_b16 v[76:77], v6 offset:28672
    v_mfma_f32_16x16x32_bf16 v[132:135], v[196:199], v[220:223], v[132:135]
    ds_read_b64_tr_b16 v[78:79], v6 offset:29184
    s_waitcnt lgkmcnt(5)
    v_mfma_f32_16x16x32_bf16 v[104:107], v[212:215], v[200:203], v[104:107]
    ds_read_b64_tr_b16 v[80:81], v6 offset:36864
    v_mfma_f32_16x16x32_bf16 v[120:123], v[216:219], v[200:203], v[120:123]
    ds_read_b64_tr_b16 v[82:83], v6 offset:37376
    v_mfma_f32_16x16x32_bf16 v[136:139], v[200:203], v[220:223], v[136:139]
    ds_read_b64_tr_b16 v[246:247], v6 offset:45056
    s_waitcnt lgkmcnt(7)
    v_mfma_f32_16x16x32_bf16 v[108:111], v[212:215], v[204:207], v[108:111]
    ds_read_b64_tr_b16 v[248:249], v6 offset:45568
    v_mfma_f32_16x16x32_bf16 v[124:127], v[216:219], v[204:207], v[124:127]
    ds_read_b128 v[32:35], v5 offset:10240
    v_mfma_f32_16x16x32_bf16 v[140:143], v[204:207], v[220:223], v[140:143]
    ds_read_b128 v[36:39], v5 offset:12288
    s_waitcnt lgkmcnt(9)
    v_mfma_f32_16x16x32_bf16 v[112:115], v[212:215], v[208:211], v[112:115]
    ds_read_b128 v[40:43], v5 offset:14336
    v_mfma_f32_16x16x32_bf16 v[128:131], v[216:219], v[208:211], v[128:131]
    v_mfma_f32_16x16x32_bf16 v[144:147], v[208:211], v[220:223], v[144:147]
    s_waitcnt lgkmcnt(3)
    v_mfma_f32_16x16x32_bf16 v[100:103], v[76:79], v[28:31], v[100:103]
    v_mfma_f32_16x16x32_bf16 v[116:119], v[80:83], v[28:31], v[116:119]
    s_waitcnt lgkmcnt(0)
    s_barrier
    v_mfma_f32_16x16x32_bf16 v[132:135], v[28:31], v[246:249], v[132:135]
    ds_read_b128 v[196:199], v4 offset:16384
    v_mfma_f32_16x16x32_bf16 v[104:107], v[76:79], v[32:35], v[104:107]
    ds_read_b64_tr_b16 v[212:213], v7 offset:0
    v_mfma_f32_16x16x32_bf16 v[120:123], v[80:83], v[32:35], v[120:123]
    ds_read_b64_tr_b16 v[214:215], v7 offset:512
    v_mfma_f32_16x16x32_bf16 v[136:139], v[32:35], v[246:249], v[136:139]
    ds_read_b64_tr_b16 v[216:217], v7 offset:8192
    v_mfma_f32_16x16x32_bf16 v[108:111], v[76:79], v[36:39], v[108:111]
    ds_read_b64_tr_b16 v[218:219], v7 offset:8704
    v_mfma_f32_16x16x32_bf16 v[124:127], v[80:83], v[36:39], v[124:127]
    ds_read_b64_tr_b16 v[220:221], v7 offset:16384
    v_mfma_f32_16x16x32_bf16 v[140:143], v[36:39], v[246:249], v[140:143]
    ds_read_b64_tr_b16 v[222:223], v7 offset:16896
    v_mfma_f32_16x16x32_bf16 v[112:115], v[76:79], v[40:43], v[112:115]
    ds_read_b128 v[200:203], v4 offset:18432
    v_mfma_f32_16x16x32_bf16 v[128:131], v[80:83], v[40:43], v[128:131]
    ds_read_b128 v[204:207], v4 offset:20480
    v_mfma_f32_16x16x32_bf16 v[144:147], v[40:43], v[246:249], v[144:147]
    ds_read_b128 v[208:211], v4 offset:22528
    s_waitcnt lgkmcnt(3)
    v_mfma_f32_16x16x32_bf16 v[100:103], v[212:215], v[196:199], v[100:103]
    ds_read_b128 v[28:31], v5 offset:16384
    v_mfma_f32_16x16x32_bf16 v[116:119], v[216:219], v[196:199], v[116:119]
    ds_read_b64_tr_b16 v[76:77], v7 offset:4096
    v_mfma_f32_16x16x32_bf16 v[132:135], v[196:199], v[220:223], v[132:135]
    ds_read_b64_tr_b16 v[78:79], v7 offset:4608
    s_waitcnt lgkmcnt(5)
    v_mfma_f32_16x16x32_bf16 v[104:107], v[212:215], v[200:203], v[104:107]
    ds_read_b64_tr_b16 v[80:81], v7 offset:12288
    v_mfma_f32_16x16x32_bf16 v[120:123], v[216:219], v[200:203], v[120:123]
    ds_read_b64_tr_b16 v[82:83], v7 offset:12800
    v_mfma_f32_16x16x32_bf16 v[136:139], v[200:203], v[220:223], v[136:139]
    ds_read_b64_tr_b16 v[246:247], v7 offset:20480
    s_waitcnt lgkmcnt(7)
    v_mfma_f32_16x16x32_bf16 v[108:111], v[212:215], v[204:207], v[108:111]
    ds_read_b64_tr_b16 v[248:249], v7 offset:20992
    v_mfma_f32_16x16x32_bf16 v[124:127], v[216:219], v[204:207], v[124:127]
    ds_read_b128 v[32:35], v5 offset:18432
    v_mfma_f32_16x16x32_bf16 v[140:143], v[204:207], v[220:223], v[140:143]
    ds_read_b128 v[36:39], v5 offset:20480
    s_waitcnt lgkmcnt(9)
    v_mfma_f32_16x16x32_bf16 v[112:115], v[212:215], v[208:211], v[112:115]
    ds_read_b128 v[40:43], v5 offset:22528
    v_mfma_f32_16x16x32_bf16 v[128:131], v[216:219], v[208:211], v[128:131]
    v_mfma_f32_16x16x32_bf16 v[144:147], v[208:211], v[220:223], v[144:147]
    s_waitcnt lgkmcnt(3)
    v_mfma_f32_16x16x32_bf16 v[100:103], v[76:79], v[28:31], v[100:103]
    v_mfma_f32_16x16x32_bf16 v[116:119], v[80:83], v[28:31], v[116:119]
    s_waitcnt lgkmcnt(0)
    s_barrier
    v_mfma_f32_16x16x32_bf16 v[132:135], v[28:31], v[246:249], v[132:135]
    ds_read_b128 v[196:199], v4 offset:24576
    v_mfma_f32_16x16x32_bf16 v[104:107], v[76:79], v[32:35], v[104:107]
    ds_read_b64_tr_b16 v[212:213], v7 offset:24576
    v_mfma_f32_16x16x32_bf16 v[120:123], v[80:83], v[32:35], v[120:123]
    ds_read_b64_tr_b16 v[214:215], v7 offset:25088
    v_mfma_f32_16x16x32_bf16 v[136:139], v[32:35], v[246:249], v[136:139]
    ds_read_b64_tr_b16 v[216:217], v7 offset:32768
    v_mfma_f32_16x16x32_bf16 v[108:111], v[76:79], v[36:39], v[108:111]
    ds_read_b64_tr_b16 v[218:219], v7 offset:33280
    v_mfma_f32_16x16x32_bf16 v[124:127], v[80:83], v[36:39], v[124:127]
    ds_read_b64_tr_b16 v[220:221], v7 offset:40960
    v_mfma_f32_16x16x32_bf16 v[140:143], v[36:39], v[246:249], v[140:143]
    ds_read_b64_tr_b16 v[222:223], v7 offset:41472
    v_mfma_f32_16x16x32_bf16 v[112:115], v[76:79], v[40:43], v[112:115]
    ds_read_b128 v[200:203], v4 offset:26624
    v_mfma_f32_16x16x32_bf16 v[128:131], v[80:83], v[40:43], v[128:131]
    ds_read_b128 v[204:207], v4 offset:28672
    v_mfma_f32_16x16x32_bf16 v[144:147], v[40:43], v[246:249], v[144:147]
    ds_read_b128 v[208:211], v4 offset:30720
    s_waitcnt lgkmcnt(3)
    v_mfma_f32_16x16x32_bf16 v[100:103], v[212:215], v[196:199], v[100:103]
    ds_read_b128 v[28:31], v5 offset:24576
    v_mfma_f32_16x16x32_bf16 v[116:119], v[216:219], v[196:199], v[116:119]
    ds_read_b64_tr_b16 v[76:77], v7 offset:28672
    v_mfma_f32_16x16x32_bf16 v[132:135], v[196:199], v[220:223], v[132:135]
    ds_read_b64_tr_b16 v[78:79], v7 offset:29184
    s_waitcnt lgkmcnt(5)
    v_mfma_f32_16x16x32_bf16 v[104:107], v[212:215], v[200:203], v[104:107]
    ds_read_b64_tr_b16 v[80:81], v7 offset:36864
    v_mfma_f32_16x16x32_bf16 v[120:123], v[216:219], v[200:203], v[120:123]
    ds_read_b64_tr_b16 v[82:83], v7 offset:37376
    v_mfma_f32_16x16x32_bf16 v[136:139], v[200:203], v[220:223], v[136:139]
    ds_read_b64_tr_b16 v[246:247], v7 offset:45056
    s_waitcnt lgkmcnt(7)
    v_mfma_f32_16x16x32_bf16 v[108:111], v[212:215], v[204:207], v[108:111]
    ds_read_b64_tr_b16 v[248:249], v7 offset:45568
    v_mfma_f32_16x16x32_bf16 v[124:127], v[216:219], v[204:207], v[124:127]
    ds_read_b128 v[32:35], v5 offset:26624
    v_mfma_f32_16x16x32_bf16 v[140:143], v[204:207], v[220:223], v[140:143]
    ds_read_b128 v[36:39], v5 offset:28672
    s_waitcnt lgkmcnt(9)
    v_mfma_f32_16x16x32_bf16 v[112:115], v[212:215], v[208:211], v[112:115]
    ds_read_b128 v[40:43], v5 offset:30720
    v_mfma_f32_16x16x32_bf16 v[128:131], v[216:219], v[208:211], v[128:131]
    v_mfma_f32_16x16x32_bf16 v[144:147], v[208:211], v[220:223], v[144:147]
    s_waitcnt lgkmcnt(3)
    v_mfma_f32_16x16x32_bf16 v[100:103], v[76:79], v[28:31], v[100:103]
    v_mfma_f32_16x16x32_bf16 v[116:119], v[80:83], v[28:31], v[116:119]
    s_waitcnt lgkmcnt(0)
    s_barrier
    v_mfma_f32_16x16x32_bf16 v[132:135], v[28:31], v[246:249], v[132:135]
    ds_read_b128 v[196:199], v4 offset:32768
    v_mfma_f32_16x16x32_bf16 v[104:107], v[76:79], v[32:35], v[104:107]
    ds_read_b64_tr_b16 v[212:213], v6 offset:0
    v_mfma_f32_16x16x32_bf16 v[120:123], v[80:83], v[32:35], v[120:123]
    ds_read_b64_tr_b16 v[214:215], v6 offset:512
    v_mfma_f32_16x16x32_bf16 v[136:139], v[32:35], v[246:249], v[136:139]
    ds_read_b64_tr_b16 v[216:217], v6 offset:8192
    v_mfma_f32_16x16x32_bf16 v[108:111], v[76:79], v[36:39], v[108:111]
    ds_read_b64_tr_b16 v[218:219], v6 offset:8704
    v_mfma_f32_16x16x32_bf16 v[124:127], v[80:83], v[36:39], v[124:127]
    ds_read_b64_tr_b16 v[220:221], v6 offset:16384
    v_mfma_f32_16x16x32_bf16 v[140:143], v[36:39], v[246:249], v[140:143]
    ds_read_b64_tr_b16 v[222:223], v6 offset:16896
    v_mfma_f32_16x16x32_bf16 v[112:115], v[76:79], v[40:43], v[112:115]
    ds_read_b128 v[200:203], v4 offset:34816
    v_mfma_f32_16x16x32_bf16 v[128:131], v[80:83], v[40:43], v[128:131]
    ds_read_b128 v[204:207], v4 offset:36864
    v_mfma_f32_16x16x32_bf16 v[144:147], v[40:43], v[246:249], v[144:147]
    ds_read_b128 v[208:211], v4 offset:38912
    s_waitcnt lgkmcnt(3)
    v_mfma_f32_16x16x32_bf16 v[100:103], v[212:215], v[196:199], v[100:103]
    ds_read_b128 v[28:31], v5 offset:32768
    v_mfma_f32_16x16x32_bf16 v[116:119], v[216:219], v[196:199], v[116:119]
    ds_read_b64_tr_b16 v[76:77], v6 offset:4096
    v_mfma_f32_16x16x32_bf16 v[132:135], v[196:199], v[220:223], v[132:135]
    ds_read_b64_tr_b16 v[78:79], v6 offset:4608
    s_waitcnt lgkmcnt(5)
    v_mfma_f32_16x16x32_bf16 v[104:107], v[212:215], v[200:203], v[104:107]
    ds_read_b64_tr_b16 v[80:81], v6 offset:12288
    v_mfma_f32_16x16x32_bf16 v[120:123], v[216:219], v[200:203], v[120:123]
    ds_read_b64_tr_b16 v[82:83], v6 offset:12800
    v_mfma_f32_16x16x32_bf16 v[136:139], v[200:203], v[220:223], v[136:139]
    ds_read_b64_tr_b16 v[246:247], v6 offset:20480
    s_waitcnt lgkmcnt(7)
    v_mfma_f32_16x16x32_bf16 v[108:111], v[212:215], v[204:207], v[108:111]
    ds_read_b64_tr_b16 v[248:249], v6 offset:20992
    v_mfma_f32_16x16x32_bf16 v[124:127], v[216:219], v[204:207], v[124:127]
    ds_read_b128 v[32:35], v5 offset:34816
    v_mfma_f32_16x16x32_bf16 v[140:143], v[204:207], v[220:223], v[140:143]
    ds_read_b128 v[36:39], v5 offset:36864
    s_waitcnt lgkmcnt(9)
    v_mfma_f32_16x16x32_bf16 v[112:115], v[212:215], v[208:211], v[112:115]
    ds_read_b128 v[40:43], v5 offset:38912
    v_mfma_f32_16x16x32_bf16 v[128:131], v[216:219], v[208:211], v[128:131]
    v_mfma_f32_16x16x32_bf16 v[144:147], v[208:211], v[220:223], v[144:147]
    s_waitcnt lgkmcnt(3)
    v_mfma_f32_16x16x32_bf16 v[100:103], v[76:79], v[28:31], v[100:103]
    v_mfma_f32_16x16x32_bf16 v[116:119], v[80:83], v[28:31], v[116:119]
    s_waitcnt lgkmcnt(0)
    s_barrier
    v_mfma_f32_16x16x32_bf16 v[132:135], v[28:31], v[246:249], v[132:135]
    ds_read_b128 v[196:199], v4 offset:40960
    v_mfma_f32_16x16x32_bf16 v[104:107], v[76:79], v[32:35], v[104:107]
    ds_read_b64_tr_b16 v[212:213], v6 offset:24576
    v_mfma_f32_16x16x32_bf16 v[120:123], v[80:83], v[32:35], v[120:123]
    ds_read_b64_tr_b16 v[214:215], v6 offset:25088
    v_mfma_f32_16x16x32_bf16 v[136:139], v[32:35], v[246:249], v[136:139]
    ds_read_b64_tr_b16 v[216:217], v6 offset:32768
    v_mfma_f32_16x16x32_bf16 v[108:111], v[76:79], v[36:39], v[108:111]
    ds_read_b64_tr_b16 v[218:219], v6 offset:33280
    v_mfma_f32_16x16x32_bf16 v[124:127], v[80:83], v[36:39], v[124:127]
    ds_read_b64_tr_b16 v[220:221], v6 offset:40960
    v_mfma_f32_16x16x32_bf16 v[140:143], v[36:39], v[246:249], v[140:143]
    ds_read_b64_tr_b16 v[222:223], v6 offset:41472
    v_mfma_f32_16x16x32_bf16 v[112:115], v[76:79], v[40:43], v[112:115]
    ds_read_b128 v[200:203], v4 offset:43008
    v_mfma_f32_16x16x32_bf16 v[128:131], v[80:83], v[40:43], v[128:131]
    ds_read_b128 v[204:207], v4 offset:45056
    v_mfma_f32_16x16x32_bf16 v[144:147], v[40:43], v[246:249], v[144:147]
    ds_read_b128 v[208:211], v4 offset:47104
    s_waitcnt lgkmcnt(3)
    v_mfma_f32_16x16x32_bf16 v[100:103], v[212:215], v[196:199], v[100:103]
    ds_read_b128 v[28:31], v5 offset:40960
    v_mfma_f32_16x16x32_bf16 v[116:119], v[216:219], v[196:199], v[116:119]
    ds_read_b64_tr_b16 v[76:77], v6 offset:28672
    v_mfma_f32_16x16x32_bf16 v[132:135], v[196:199], v[220:223], v[132:135]
    ds_read_b64_tr_b16 v[78:79], v6 offset:29184
    s_waitcnt lgkmcnt(5)
    v_mfma_f32_16x16x32_bf16 v[104:107], v[212:215], v[200:203], v[104:107]
    ds_read_b64_tr_b16 v[80:81], v6 offset:36864
    v_mfma_f32_16x16x32_bf16 v[120:123], v[216:219], v[200:203], v[120:123]
    ds_read_b64_tr_b16 v[82:83], v6 offset:37376
    v_mfma_f32_16x16x32_bf16 v[136:139], v[200:203], v[220:223], v[136:139]
    ds_read_b64_tr_b16 v[246:247], v6 offset:45056
    s_waitcnt lgkmcnt(7)
    v_mfma_f32_16x16x32_bf16 v[108:111], v[212:215], v[204:207], v[108:111]
    ds_read_b64_tr_b16 v[248:249], v6 offset:45568
    v_mfma_f32_16x16x32_bf16 v[124:127], v[216:219], v[204:207], v[124:127]
    ds_read_b128 v[32:35], v5 offset:43008
    v_mfma_f32_16x16x32_bf16 v[140:143], v[204:207], v[220:223], v[140:143]
    ds_read_b128 v[36:39], v5 offset:45056
    s_waitcnt lgkmcnt(9)
    v_mfma_f32_16x16x32_bf16 v[112:115], v[212:215], v[208:211], v[112:115]
    ds_read_b128 v[40:43], v5 offset:47104
    v_mfma_f32_16x16x32_bf16 v[128:131], v[216:219], v[208:211], v[128:131]
    v_mfma_f32_16x16x32_bf16 v[144:147], v[208:211], v[220:223], v[144:147]
    s_waitcnt lgkmcnt(3)
    v_mfma_f32_16x16x32_bf16 v[100:103], v[76:79], v[28:31], v[100:103]
    v_mfma_f32_16x16x32_bf16 v[116:119], v[80:83], v[28:31], v[116:119]
    s_waitcnt lgkmcnt(0)
    s_barrier
    v_mfma_f32_16x16x32_bf16 v[132:135], v[28:31], v[246:249], v[132:135]
    ds_read_b128 v[196:199], v4 offset:49152
    v_mfma_f32_16x16x32_bf16 v[104:107], v[76:79], v[32:35], v[104:107]
    ds_read_b64_tr_b16 v[212:213], v7 offset:0
    v_mfma_f32_16x16x32_bf16 v[120:123], v[80:83], v[32:35], v[120:123]
    ds_read_b64_tr_b16 v[214:215], v7 offset:512
    v_mfma_f32_16x16x32_bf16 v[136:139], v[32:35], v[246:249], v[136:139]
    ds_read_b64_tr_b16 v[216:217], v7 offset:8192
    v_mfma_f32_16x16x32_bf16 v[108:111], v[76:79], v[36:39], v[108:111]
    ds_read_b64_tr_b16 v[218:219], v7 offset:8704
    v_mfma_f32_16x16x32_bf16 v[124:127], v[80:83], v[36:39], v[124:127]
    ds_read_b64_tr_b16 v[220:221], v7 offset:16384
    v_mfma_f32_16x16x32_bf16 v[140:143], v[36:39], v[246:249], v[140:143]
    ds_read_b64_tr_b16 v[222:223], v7 offset:16896
    v_mfma_f32_16x16x32_bf16 v[112:115], v[76:79], v[40:43], v[112:115]
    ds_read_b128 v[200:203], v4 offset:51200
    v_mfma_f32_16x16x32_bf16 v[128:131], v[80:83], v[40:43], v[128:131]
    ds_read_b128 v[204:207], v4 offset:53248
    v_mfma_f32_16x16x32_bf16 v[144:147], v[40:43], v[246:249], v[144:147]
    ds_read_b128 v[208:211], v4 offset:55296
    s_waitcnt lgkmcnt(3)
    v_mfma_f32_16x16x32_bf16 v[100:103], v[212:215], v[196:199], v[100:103]
    ds_read_b128 v[28:31], v5 offset:49152
    v_mfma_f32_16x16x32_bf16 v[116:119], v[216:219], v[196:199], v[116:119]
    ds_read_b64_tr_b16 v[76:77], v7 offset:4096
    v_mfma_f32_16x16x32_bf16 v[132:135], v[196:199], v[220:223], v[132:135]
    ds_read_b64_tr_b16 v[78:79], v7 offset:4608
    s_waitcnt lgkmcnt(5)
    v_mfma_f32_16x16x32_bf16 v[104:107], v[212:215], v[200:203], v[104:107]
    ds_read_b64_tr_b16 v[80:81], v7 offset:12288
    v_mfma_f32_16x16x32_bf16 v[120:123], v[216:219], v[200:203], v[120:123]
    ds_read_b64_tr_b16 v[82:83], v7 offset:12800
    v_mfma_f32_16x16x32_bf16 v[136:139], v[200:203], v[220:223], v[136:139]
    ds_read_b64_tr_b16 v[246:247], v7 offset:20480
    s_waitcnt lgkmcnt(7)
    v_mfma_f32_16x16x32_bf16 v[108:111], v[212:215], v[204:207], v[108:111]
    ds_read_b64_tr_b16 v[248:249], v7 offset:20992
    v_mfma_f32_16x16x32_bf16 v[124:127], v[216:219], v[204:207], v[124:127]
    ds_read_b128 v[32:35], v5 offset:51200
    v_mfma_f32_16x16x32_bf16 v[140:143], v[204:207], v[220:223], v[140:143]
    ds_read_b128 v[36:39], v5 offset:53248
    s_waitcnt lgkmcnt(9)
    v_mfma_f32_16x16x32_bf16 v[112:115], v[212:215], v[208:211], v[112:115]
    ds_read_b128 v[40:43], v5 offset:55296
    v_mfma_f32_16x16x32_bf16 v[128:131], v[216:219], v[208:211], v[128:131]
    v_mfma_f32_16x16x32_bf16 v[144:147], v[208:211], v[220:223], v[144:147]
    s_waitcnt lgkmcnt(3)
    v_mfma_f32_16x16x32_bf16 v[100:103], v[76:79], v[28:31], v[100:103]
    v_mfma_f32_16x16x32_bf16 v[116:119], v[80:83], v[28:31], v[116:119]
    s_waitcnt lgkmcnt(0)
    s_barrier
    v_mfma_f32_16x16x32_bf16 v[132:135], v[28:31], v[246:249], v[132:135]
    ds_read_b128 v[196:199], v4 offset:57344
    v_mfma_f32_16x16x32_bf16 v[104:107], v[76:79], v[32:35], v[104:107]
    ds_read_b64_tr_b16 v[212:213], v7 offset:24576
    v_mfma_f32_16x16x32_bf16 v[120:123], v[80:83], v[32:35], v[120:123]
    ds_read_b64_tr_b16 v[214:215], v7 offset:25088
    v_mfma_f32_16x16x32_bf16 v[136:139], v[32:35], v[246:249], v[136:139]
    ds_read_b64_tr_b16 v[216:217], v7 offset:32768
    v_mfma_f32_16x16x32_bf16 v[108:111], v[76:79], v[36:39], v[108:111]
    ds_read_b64_tr_b16 v[218:219], v7 offset:33280
    v_mfma_f32_16x16x32_bf16 v[124:127], v[80:83], v[36:39], v[124:127]
    ds_read_b64_tr_b16 v[220:221], v7 offset:40960
    v_mfma_f32_16x16x32_bf16 v[140:143], v[36:39], v[246:249], v[140:143]
    ds_read_b64_tr_b16 v[222:223], v7 offset:41472
    v_mfma_f32_16x16x32_bf16 v[112:115], v[76:79], v[40:43], v[112:115]
    ds_read_b128 v[200:203], v4 offset:59392
    v_mfma_f32_16x16x32_bf16 v[128:131], v[80:83], v[40:43], v[128:131]
    ds_read_b128 v[204:207], v4 offset:61440
    v_mfma_f32_16x16x32_bf16 v[144:147], v[40:43], v[246:249], v[144:147]
    ds_read_b128 v[208:211], v4 offset:63488
    s_waitcnt lgkmcnt(3)
    v_mfma_f32_16x16x32_bf16 v[100:103], v[212:215], v[196:199], v[100:103]
    ds_read_b128 v[28:31], v5 offset:57344
    v_mfma_f32_16x16x32_bf16 v[116:119], v[216:219], v[196:199], v[116:119]
    ds_read_b64_tr_b16 v[76:77], v7 offset:28672
    v_mfma_f32_16x16x32_bf16 v[132:135], v[196:199], v[220:223], v[132:135]
    ds_read_b64_tr_b16 v[78:79], v7 offset:29184
    s_waitcnt lgkmcnt(5)
    v_mfma_f32_16x16x32_bf16 v[104:107], v[212:215], v[200:203], v[104:107]
    ds_read_b64_tr_b16 v[80:81], v7 offset:36864
    v_mfma_f32_16x16x32_bf16 v[120:123], v[216:219], v[200:203], v[120:123]
    ds_read_b64_tr_b16 v[82:83], v7 offset:37376
    v_mfma_f32_16x16x32_bf16 v[136:139], v[200:203], v[220:223], v[136:139]
    ds_read_b64_tr_b16 v[246:247], v7 offset:45056
    s_waitcnt lgkmcnt(7)
    v_mfma_f32_16x16x32_bf16 v[108:111], v[212:215], v[204:207], v[108:111]
    ds_read_b64_tr_b16 v[248:249], v7 offset:45568
    v_mfma_f32_16x16x32_bf16 v[124:127], v[216:219], v[204:207], v[124:127]
    ds_read_b128 v[32:35], v5 offset:59392
    v_mfma_f32_16x16x32_bf16 v[140:143], v[204:207], v[220:223], v[140:143]
    ds_read_b128 v[36:39], v5 offset:61440
    s_waitcnt lgkmcnt(9)
    v_mfma_f32_16x16x32_bf16 v[112:115], v[212:215], v[208:211], v[112:115]
    ds_read_b128 v[40:43], v5 offset:63488
    v_mfma_f32_16x16x32_bf16 v[128:131], v[216:219], v[208:211], v[128:131]
    v_mfma_f32_16x16x32_bf16 v[144:147], v[208:211], v[220:223], v[144:147]
    s_waitcnt lgkmcnt(3)
    v_mfma_f32_16x16x32_bf16 v[100:103], v[76:79], v[28:31], v[100:103]
    v_mfma_f32_16x16x32_bf16 v[116:119], v[80:83], v[28:31], v[116:119]
    s_waitcnt lgkmcnt(0)
    v_mfma_f32_16x16x32_bf16 v[132:135], v[28:31], v[246:249], v[132:135]
    v_mfma_f32_16x16x32_bf16 v[104:107], v[76:79], v[32:35], v[104:107]
    v_mfma_f32_16x16x32_bf16 v[120:123], v[80:83], v[32:35], v[120:123]
    v_mfma_f32_16x16x32_bf16 v[136:139], v[32:35], v[246:249], v[136:139]
    v_mfma_f32_16x16x32_bf16 v[108:111], v[76:79], v[36:39], v[108:111]
    v_mfma_f32_16x16x32_bf16 v[124:127], v[80:83], v[36:39], v[124:127]
    v_mfma_f32_16x16x32_bf16 v[140:143], v[36:39], v[246:249], v[140:143]
    v_mfma_f32_16x16x32_bf16 v[112:115], v[76:79], v[40:43], v[112:115]
    v_mfma_f32_16x16x32_bf16 v[128:131], v[80:83], v[40:43], v[128:131]
    v_mfma_f32_16x16x32_bf16 v[144:147], v[40:43], v[246:249], v[144:147]
    s_nop 4
    v_cvt_pk_bf16_f32 v116, v116, v117
    v_cvt_pk_bf16_f32 v117, v118, v119
    v_cvt_pk_bf16_f32 v118, v120, v121
    v_cvt_pk_bf16_f32 v119, v122, v123
    s_nop 0
    v_permlane16_swap_b32 v116, v118
    v_permlane16_swap_b32 v117, v119
    buffer_store_dwordx4 v[116:119], v11, s[8:11], s62 offen offset:0 sc1
    v_cvt_pk_bf16_f32 v124, v124, v125
    v_cvt_pk_bf16_f32 v125, v126, v127
    v_cvt_pk_bf16_f32 v126, v128, v129
    v_cvt_pk_bf16_f32 v127, v130, v131
    s_nop 0
    v_permlane16_swap_b32 v124, v126
    v_permlane16_swap_b32 v125, v127
    buffer_store_dwordx4 v[124:127], v11, s[8:11], s62 offen offset:1024 sc1
    v_cvt_pk_bf16_f32 v132, v132, v133
    v_cvt_pk_bf16_f32 v133, v134, v135
    v_cvt_pk_bf16_f32 v134, v136, v137
    v_cvt_pk_bf16_f32 v135, v138, v139
    buffer_store_dwordx4 v[132:135], v2, s[8:11], s63 offen offset:0 sc1
    v_cvt_pk_bf16_f32 v140, v140, v141
    v_cvt_pk_bf16_f32 v141, v142, v143
    v_cvt_pk_bf16_f32 v142, v144, v145
    v_cvt_pk_bf16_f32 v143, v146, v147
    buffer_store_dwordx4 v[140:143], v2, s[8:11], s63 offen offset:1024 sc1
    s_barrier
    ds_read_b128 v[196:199], v4 offset:0
    ds_read_b64_tr_b16 v[212:213], v6 offset:0
    ds_read_b64_tr_b16 v[214:215], v6 offset:512
    ds_read_b64_tr_b16 v[216:217], v6 offset:8192
    ds_read_b64_tr_b16 v[218:219], v6 offset:8704
    ds_read_b64_tr_b16 v[220:221], v6 offset:16384
    ds_read_b64_tr_b16 v[222:223], v6 offset:16896
    ds_read_b128 v[200:203], v4 offset:2048
    ds_read_b128 v[204:207], v4 offset:4096
    ds_read_b128 v[208:211], v4 offset:6144
    v_pk_mul_f32 v[100:101], v[100:101], s[66:67]
    v_pk_mul_f32 v[102:103], v[102:103], s[66:67]
    v_pk_mul_f32 v[104:105], v[104:105], s[66:67]
    v_pk_mul_f32 v[106:107], v[106:107], s[66:67]
    v_pk_mul_f32 v[108:109], v[108:109], s[66:67]
    v_pk_mul_f32 v[110:111], v[110:111], s[66:67]
    v_pk_mul_f32 v[112:113], v[112:113], s[66:67]
    v_pk_mul_f32 v[114:115], v[114:115], s[66:67]
    v_cvt_pk_bf16_f32 v100, v100, v101
    v_cvt_pk_bf16_f32 v101, v102, v103
    v_cvt_pk_bf16_f32 v102, v104, v105
    v_cvt_pk_bf16_f32 v103, v106, v107
    s_nop 0
    v_permlane16_swap_b32 v100, v102
    v_permlane16_swap_b32 v101, v103
    buffer_store_dwordx4 v[100:103], v2, s[8:11], s61 offen offset:0 sc1
    v_cvt_pk_bf16_f32 v108, v108, v109
    v_cvt_pk_bf16_f32 v109, v110, v111
    v_cvt_pk_bf16_f32 v110, v112, v113
    v_cvt_pk_bf16_f32 v111, v114, v115
    s_nop 0
    v_permlane16_swap_b32 v108, v110
    v_permlane16_swap_b32 v109, v111
    buffer_store_dwordx4 v[108:111], v2, s[8:11], s61 offen offset:1024 sc1
    s_waitcnt lgkmcnt(3)
    v_mfma_f32_16x16x32_bf16 v[148:151], v[212:215], v[196:199], 0
    ds_read_b128 v[28:31], v5 offset:0
    v_mfma_f32_16x16x32_bf16 v[164:167], v[196:199], v[216:219], 0
    ds_read_b64_tr_b16 v[76:77], v6 offset:4096
    v_mfma_f32_16x16x32_bf16 v[180:183], v[196:199], v[220:223], 0
    ds_read_b64_tr_b16 v[78:79], v6 offset:4608
    s_waitcnt lgkmcnt(5)
    v_mfma_f32_16x16x32_bf16 v[152:155], v[212:215], v[200:203], 0
    ds_read_b64_tr_b16 v[80:81], v6 offset:12288
    v_mfma_f32_16x16x32_bf16 v[168:171], v[200:203], v[216:219], 0
    ds_read_b64_tr_b16 v[82:83], v6 offset:12800
    v_mfma_f32_16x16x32_bf16 v[184:187], v[200:203], v[220:223], 0
    ds_read_b64_tr_b16 v[246:247], v6 offset:20480
    s_waitcnt lgkmcnt(7)
    v_mfma_f32_16x16x32_bf16 v[156:159], v[212:215], v[204:207], 0
    ds_read_b64_tr_b16 v[248:249], v6 offset:20992
    v_mfma_f32_16x16x32_bf16 v[172:175], v[204:207], v[216:219], 0
    ds_read_b128 v[32:35], v5 offset:2048
    v_mfma_f32_16x16x32_bf16 v[188:191], v[204:207], v[220:223], 0
    ds_read_b128 v[36:39], v5 offset:4096
    s_waitcnt lgkmcnt(9)
    v_mfma_f32_16x16x32_bf16 v[160:163], v[212:215], v[208:211], 0
    ds_read_b128 v[40:43], v5 offset:6144
    v_mfma_f32_16x16x32_bf16 v[176:179], v[208:211], v[216:219], 0
    v_mfma_f32_16x16x32_bf16 v[192:195], v[208:211], v[220:223], 0
    s_waitcnt lgkmcnt(3)
    v_mfma_f32_16x16x32_bf16 v[148:151], v[76:79], v[28:31], v[148:151]
    v_mfma_f32_16x16x32_bf16 v[164:167], v[28:31], v[80:83], v[164:167]
    s_waitcnt lgkmcnt(0)
    s_barrier
    v_mfma_f32_16x16x32_bf16 v[180:183], v[28:31], v[246:249], v[180:183]
    ds_read_b128 v[196:199], v4 offset:8192
    v_mfma_f32_16x16x32_bf16 v[152:155], v[76:79], v[32:35], v[152:155]
    ds_read_b64_tr_b16 v[212:213], v6 offset:24576
    v_mfma_f32_16x16x32_bf16 v[168:171], v[32:35], v[80:83], v[168:171]
    ds_read_b64_tr_b16 v[214:215], v6 offset:25088
    v_mfma_f32_16x16x32_bf16 v[184:187], v[32:35], v[246:249], v[184:187]
    ds_read_b64_tr_b16 v[216:217], v6 offset:32768
    v_mfma_f32_16x16x32_bf16 v[156:159], v[76:79], v[36:39], v[156:159]
    ds_read_b64_tr_b16 v[218:219], v6 offset:33280
    v_mfma_f32_16x16x32_bf16 v[172:175], v[36:39], v[80:83], v[172:175]
    ds_read_b64_tr_b16 v[220:221], v6 offset:40960
    v_mfma_f32_16x16x32_bf16 v[188:191], v[36:39], v[246:249], v[188:191]
    ds_read_b64_tr_b16 v[222:223], v6 offset:41472
    v_mfma_f32_16x16x32_bf16 v[160:163], v[76:79], v[40:43], v[160:163]
    ds_read_b128 v[200:203], v4 offset:10240
    v_mfma_f32_16x16x32_bf16 v[176:179], v[40:43], v[80:83], v[176:179]
    ds_read_b128 v[204:207], v4 offset:12288
    v_mfma_f32_16x16x32_bf16 v[192:195], v[40:43], v[246:249], v[192:195]
    ds_read_b128 v[208:211], v4 offset:14336
    s_waitcnt lgkmcnt(3)
    v_mfma_f32_16x16x32_bf16 v[148:151], v[212:215], v[196:199], v[148:151]
    ds_read_b128 v[28:31], v5 offset:8192
    v_mfma_f32_16x16x32_bf16 v[164:167], v[196:199], v[216:219], v[164:167]
    ds_read_b64_tr_b16 v[76:77], v6 offset:28672
    v_mfma_f32_16x16x32_bf16 v[180:183], v[196:199], v[220:223], v[180:183]
    ds_read_b64_tr_b16 v[78:79], v6 offset:29184
    s_waitcnt lgkmcnt(5)
    v_mfma_f32_16x16x32_bf16 v[152:155], v[212:215], v[200:203], v[152:155]
    ds_read_b64_tr_b16 v[80:81], v6 offset:36864
    v_mfma_f32_16x16x32_bf16 v[168:171], v[200:203], v[216:219], v[168:171]
    ds_read_b64_tr_b16 v[82:83], v6 offset:37376
    v_mfma_f32_16x16x32_bf16 v[184:187], v[200:203], v[220:223], v[184:187]
    ds_read_b64_tr_b16 v[246:247], v6 offset:45056
    s_waitcnt lgkmcnt(7)
    v_mfma_f32_16x16x32_bf16 v[156:159], v[212:215], v[204:207], v[156:159]
    ds_read_b64_tr_b16 v[248:249], v6 offset:45568
    v_mfma_f32_16x16x32_bf16 v[172:175], v[204:207], v[216:219], v[172:175]
    ds_read_b128 v[32:35], v5 offset:10240
    v_mfma_f32_16x16x32_bf16 v[188:191], v[204:207], v[220:223], v[188:191]
    ds_read_b128 v[36:39], v5 offset:12288
    s_waitcnt lgkmcnt(9)
    v_mfma_f32_16x16x32_bf16 v[160:163], v[212:215], v[208:211], v[160:163]
    ds_read_b128 v[40:43], v5 offset:14336
    v_mfma_f32_16x16x32_bf16 v[176:179], v[208:211], v[216:219], v[176:179]
    v_mfma_f32_16x16x32_bf16 v[192:195], v[208:211], v[220:223], v[192:195]
    s_getreg_b32 s50, hwreg(HW_REG_IB_STS, 0, 4)
    s_cmp_eq_u32 s50, 0
    s_cbranch_scc1 L_f1s18
    s_waitcnt lgkmcnt(3)
    v_mfma_f32_16x16x32_bf16 v[148:151], v[76:79], v[28:31], v[148:151]
    v_mfma_f32_16x16x32_bf16 v[164:167], v[28:31], v[80:83], v[164:167]
    s_waitcnt lgkmcnt(0)
    s_barrier
    v_mfma_f32_16x16x32_bf16 v[180:183], v[28:31], v[246:249], v[180:183]
    ds_read_b128 v[196:199], v4 offset:16384
    v_mfma_f32_16x16x32_bf16 v[152:155], v[76:79], v[32:35], v[152:155]
    ds_read_b64_tr_b16 v[212:213], v7 offset:0
    v_mfma_f32_16x16x32_bf16 v[168:171], v[32:35], v[80:83], v[168:171]
    ds_read_b64_tr_b16 v[214:215], v7 offset:512
    v_mfma_f32_16x16x32_bf16 v[184:187], v[32:35], v[246:249], v[184:187]
    ds_read_b64_tr_b16 v[216:217], v7 offset:8192
    v_mfma_f32_16x16x32_bf16 v[156:159], v[76:79], v[36:39], v[156:159]
    ds_read_b64_tr_b16 v[218:219], v7 offset:8704
    v_mfma_f32_16x16x32_bf16 v[172:175], v[36:39], v[80:83], v[172:175]
    ds_read_b64_tr_b16 v[220:221], v7 offset:16384
    v_mfma_f32_16x16x32_bf16 v[188:191], v[36:39], v[246:249], v[188:191]
    ds_read_b64_tr_b16 v[222:223], v7 offset:16896
    v_mfma_f32_16x16x32_bf16 v[160:163], v[76:79], v[40:43], v[160:163]
    ds_read_b128 v[200:203], v4 offset:18432
    v_mfma_f32_16x16x32_bf16 v[176:179], v[40:43], v[80:83], v[176:179]
    ds_read_b128 v[204:207], v4 offset:20480
    v_mfma_f32_16x16x32_bf16 v[192:195], v[40:43], v[246:249], v[192:195]
    ds_read_b128 v[208:211], v4 offset:22528
    s_getreg_b32 s50, hwreg(HW_REG_IB_STS, 0, 4)
    s_cmp_eq_u32 s50, 0
    s_cbranch_scc1 L_f1s19
    s_waitcnt lgkmcnt(3)
    v_mfma_f32_16x16x32_bf16 v[148:151], v[212:215], v[196:199], v[148:151]
    ds_read_b128 v[28:31], v5 offset:16384
    v_mfma_f32_16x16x32_bf16 v[164:167], v[196:199], v[216:219], v[164:167]
    ds_read_b64_tr_b16 v[76:77], v7 offset:4096
    v_mfma_f32_16x16x32_bf16 v[180:183], v[196:199], v[220:223], v[180:183]
    ds_read_b64_tr_b16 v[78:79], v7 offset:4608
    s_waitcnt lgkmcnt(5)
    v_mfma_f32_16x16x32_bf16 v[152:155], v[212:215], v[200:203], v[152:155]
    ds_read_b64_tr_b16 v[80:81], v7 offset:12288
    v_mfma_f32_16x16x32_bf16 v[168:171], v[200:203], v[216:219], v[168:171]
    ds_read_b64_tr_b16 v[82:83], v7 offset:12800
    v_mfma_f32_16x16x32_bf16 v[184:187], v[200:203], v[220:223], v[184:187]
    ds_read_b64_tr_b16 v[246:247], v7 offset:20480
    s_waitcnt lgkmcnt(7)
    v_mfma_f32_16x16x32_bf16 v[156:159], v[212:215], v[204:207], v[156:159]
    ds_read_b64_tr_b16 v[248:249], v7 offset:20992
    v_mfma_f32_16x16x32_bf16 v[172:175], v[204:207], v[216:219], v[172:175]
    ds_read_b128 v[32:35], v5 offset:18432
    v_mfma_f32_16x16x32_bf16 v[188:191], v[204:207], v[220:223], v[188:191]
    ds_read_b128 v[36:39], v5 offset:20480
    s_waitcnt lgkmcnt(9)
    v_mfma_f32_16x16x32_bf16 v[160:163], v[212:215], v[208:211], v[160:163]
    ds_read_b128 v[40:43], v5 offset:22528
    v_mfma_f32_16x16x32_bf16 v[176:179], v[208:211], v[216:219], v[176:179]
    v_mfma_f32_16x16x32_bf16 v[192:195], v[208:211], v[220:223], v[192:195]
    s_getreg_b32 s50, hwreg(HW_REG_IB_STS, 0, 4)
    s_cmp_eq_u32 s50, 0
    s_cbranch_scc1 L_f1s20
    s_waitcnt lgkmcnt(3)
    v_mfma_f32_16x16x32_bf16 v[148:151], v[76:79], v[28:31], v[148:151]
    v_mfma_f32_16x16x32_bf16 v[164:167], v[28:31], v[80:83], v[164:167]
    s_waitcnt lgkmcnt(0)
    s_barrier
    v_mfma_f32_16x16x32_bf16 v[180:183], v[28:31], v[246:249], v[180:183]
    ds_read_b128 v[196:199], v4 offset:24576
    v_mfma_f32_16x16x32_bf16 v[152:155], v[76:79], v[32:35], v[152:155]
    ds_read_b64_tr_b16 v[212:213], v7 offset:24576
    v_mfma_f32_16x16x32_bf16 v[168:171], v[32:35], v[80:83], v[168:171]
    ds_read_b64_tr_b16 v[214:215], v7 offset:25088
    v_mfma_f32_16x16x32_bf16 v[184:187], v[32:35], v[246:249], v[184:187]
    ds_read_b64_tr_b16 v[216:217], v7 offset:32768
    v_mfma_f32_16x16x32_bf16 v[156:159], v[76:79], v[36:39], v[156:159]
    ds_read_b64_tr_b16 v[218:219], v7 offset:33280
    v_mfma_f32_16x16x32_bf16 v[172:175], v[36:39], v[80:83], v[172:175]
    ds_read_b64_tr_b16 v[220:221], v7 offset:40960
    v_mfma_f32_16x16x32_bf16 v[188:191], v[36:39], v[246:249], v[188:191]
    ds_read_b64_tr_b16 v[222:223], v7 offset:41472
    v_mfma_f32_16x16x32_bf16 v[160:163], v[76:79], v[40:43], v[160:163]
    ds_read_b128 v[200:203], v4 offset:26624
    v_mfma_f32_16x16x32_bf16 v[176:179], v[40:43], v[80:83], v[176:179]
    ds_read_b128 v[204:207], v4 offset:28672
    v_mfma_f32_16x16x32_bf16 v[192:195], v[40:43], v[246:249], v[192:195]
    ds_read_b128 v[208:211], v4 offset:30720
    s_getreg_b32 s50, hwreg(HW_REG_IB_STS, 0, 4)
    s_cmp_eq_u32 s50, 0
    s_cbranch_scc1 L_f1s21
    s_waitcnt lgkmcnt(3)
    v_mfma_f32_16x16x32_bf16 v[148:151], v[212:215], v[196:199], v[148:151]
    ds_read_b128 v[28:31], v5 offset:24576
    v_mfma_f32_16x16x32_bf16 v[164:167], v[196:199], v[216:219], v[164:167]
    ds_read_b64_tr_b16 v[76:77], v7 offset:28672
    v_mfma_f32_16x16x32_bf16 v[180:183], v[196:199], v[220:223], v[180:183]
    ds_read_b64_tr_b16 v[78:79], v7 offset:29184
    s_waitcnt lgkmcnt(5)
    v_mfma_f32_16x16x32_bf16 v[152:155], v[212:215], v[200:203], v[152:155]
    ds_read_b64_tr_b16 v[80:81], v7 offset:36864
    v_mfma_f32_16x16x32_bf16 v[168:171], v[200:203], v[216:219], v[168:171]
    ds_read_b64_tr_b16 v[82:83], v7 offset:37376
    v_mfma_f32_16x16x32_bf16 v[184:187], v[200:203], v[220:223], v[184:187]
    ds_read_b64_tr_b16 v[246:247], v7 offset:45056
    s_waitcnt lgkmcnt(7)
    v_mfma_f32_16x16x32_bf16 v[156:159], v[212:215], v[204:207], v[156:159]
    ds_read_b64_tr_b16 v[248:249], v7 offset:45568
    v_mfma_f32_16x16x32_bf16 v[172:175], v[204:207], v[216:219], v[172:175]
    ds_read_b128 v[32:35], v5 offset:26624
    v_mfma_f32_16x16x32_bf16 v[188:191], v[204:207], v[220:223], v[188:191]
    ds_read_b128 v[36:39], v5 offset:28672
    s_waitcnt lgkmcnt(9)
    v_mfma_f32_16x16x32_bf16 v[160:163], v[212:215], v[208:211], v[160:163]
    ds_read_b128 v[40:43], v5 offset:30720
    v_mfma_f32_16x16x32_bf16 v[176:179], v[208:211], v[216:219], v[176:179]
    v_mfma_f32_16x16x32_bf16 v[192:195], v[208:211], v[220:223], v[192:195]
    s_getreg_b32 s50, hwreg(HW_REG_IB_STS, 0, 4)
    s_cmp_eq_u32 s50, 0
    s_cbranch_scc1 L_f1s22
    s_waitcnt lgkmcnt(3)
    v_mfma_f32_16x16x32_bf16 v[148:151], v[76:79], v[28:31], v[148:151]
    v_mfma_f32_16x16x32_bf16 v[164:167], v[28:31], v[80:83], v[164:167]
    s_waitcnt lgkmcnt(0)
    s_barrier
    v_mfma_f32_16x16x32_bf16 v[180:183], v[28:31], v[246:249], v[180:183]
    ds_read_b128 v[196:199], v4 offset:32768
    v_mfma_f32_16x16x32_bf16 v[152:155], v[76:79], v[32:35], v[152:155]
    ds_read_b64_tr_b16 v[212:213], v6 offset:0
    v_mfma_f32_16x16x32_bf16 v[168:171], v[32:35], v[80:83], v[168:171]
    ds_read_b64_tr_b16 v[214:215], v6 offset:512
    v_mfma_f32_16x16x32_bf16 v[184:187], v[32:35], v[246:249], v[184:187]
    ds_read_b64_tr_b16 v[216:217], v6 offset:8192
    v_mfma_f32_16x16x32_bf16 v[156:159], v[76:79], v[36:39], v[156:159]
    ds_read_b64_tr_b16 v[218:219], v6 offset:8704
    v_mfma_f32_16x16x32_bf16 v[172:175], v[36:39], v[80:83], v[172:175]
    ds_read_b64_tr_b16 v[220:221], v6 offset:16384
    v_mfma_f32_16x16x32_bf16 v[188:191], v[36:39], v[246:249], v[188:191]
    ds_read_b64_tr_b16 v[222:223], v6 offset:16896
    v_mfma_f32_16x16x32_bf16 v[160:163], v[76:79], v[40:43], v[160:163]
    ds_read_b128 v[200:203], v4 offset:34816
    v_mfma_f32_16x16x32_bf16 v[176:179], v[40:43], v[80:83], v[176:179]
    ds_read_b128 v[204:207], v4 offset:36864
    v_mfma_f32_16x16x32_bf16 v[192:195], v[40:43], v[246:249], v[192:195]
    ds_read_b128 v[208:211], v4 offset:38912
    s_getreg_b32 s50, hwreg(HW_REG_IB_STS, 0, 4)
    s_cmp_eq_u32 s50, 0
    s_cbranch_scc1 L_f1s23
    s_waitcnt lgkmcnt(3)
    v_mfma_f32_16x16x32_bf16 v[148:151], v[212:215], v[196:199], v[148:151]
    ds_read_b128 v[28:31], v5 offset:32768
    v_mfma_f32_16x16x32_bf16 v[164:167], v[196:199], v[216:219], v[164:167]
    ds_read_b64_tr_b16 v[76:77], v6 offset:4096
    v_mfma_f32_16x16x32_bf16 v[180:183], v[196:199], v[220:223], v[180:183]
    ds_read_b64_tr_b16 v[78:79], v6 offset:4608
    s_waitcnt lgkmcnt(5)
    v_mfma_f32_16x16x32_bf16 v[152:155], v[212:215], v[200:203], v[152:155]
    ds_read_b64_tr_b16 v[80:81], v6 offset:12288
    v_mfma_f32_16x16x32_bf16 v[168:171], v[200:203], v[216:219], v[168:171]
    ds_read_b64_tr_b16 v[82:83], v6 offset:12800
    v_mfma_f32_16x16x32_bf16 v[184:187], v[200:203], v[220:223], v[184:187]
    ds_read_b64_tr_b16 v[246:247], v6 offset:20480
    s_waitcnt lgkmcnt(7)
    v_mfma_f32_16x16x32_bf16 v[156:159], v[212:215], v[204:207], v[156:159]
    ds_read_b64_tr_b16 v[248:249], v6 offset:20992
    v_mfma_f32_16x16x32_bf16 v[172:175], v[204:207], v[216:219], v[172:175]
    ds_read_b128 v[32:35], v5 offset:34816
    v_mfma_f32_16x16x32_bf16 v[188:191], v[204:207], v[220:223], v[188:191]
    ds_read_b128 v[36:39], v5 offset:36864
    s_waitcnt lgkmcnt(9)
    v_mfma_f32_16x16x32_bf16 v[160:163], v[212:215], v[208:211], v[160:163]
    ds_read_b128 v[40:43], v5 offset:38912
    v_mfma_f32_16x16x32_bf16 v[176:179], v[208:211], v[216:219], v[176:179]
    v_mfma_f32_16x16x32_bf16 v[192:195], v[208:211], v[220:223], v[192:195]
    s_getreg_b32 s50, hwreg(HW_REG_IB_STS, 0, 4)
    s_cmp_eq_u32 s50, 0
    s_cbranch_scc1 L_f1s24
    s_waitcnt lgkmcnt(3)
    v_mfma_f32_16x16x32_bf16 v[148:151], v[76:79], v[28:31], v[148:151]
    v_mfma_f32_16x16x32_bf16 v[164:167], v[28:31], v[80:83], v[164:167]
    s_waitcnt lgkmcnt(0)
    s_barrier
    v_mfma_f32_16x16x32_bf16 v[180:183], v[28:31], v[246:249], v[180:183]
    ds_read_b128 v[196:199], v4 offset:40960
    v_mfma_f32_16x16x32_bf16 v[152:155], v[76:79], v[32:35], v[152:155]
    ds_read_b64_tr_b16 v[212:213], v6 offset:24576
    v_mfma_f32_16x16x32_bf16 v[168:171], v[32:35], v[80:83], v[168:171]
    ds_read_b64_tr_b16 v[214:215], v6 offset:25088
    v_mfma_f32_16x16x32_bf16 v[184:187], v[32:35], v[246:249], v[184:187]
    ds_read_b64_tr_b16 v[216:217], v6 offset:32768
    v_mfma_f32_16x16x32_bf16 v[156:159], v[76:79], v[36:39], v[156:159]
    ds_read_b64_tr_b16 v[218:219], v6 offset:33280
    v_mfma_f32_16x16x32_bf16 v[172:175], v[36:39], v[80:83], v[172:175]
    ds_read_b64_tr_b16 v[220:221], v6 offset:40960
    v_mfma_f32_16x16x32_bf16 v[188:191], v[36:39], v[246:249], v[188:191]
    ds_read_b64_tr_b16 v[222:223], v6 offset:41472
    v_mfma_f32_16x16x32_bf16 v[160:163], v[76:79], v[40:43], v[160:163]
    ds_read_b128 v[200:203], v4 offset:43008
    v_mfma_f32_16x16x32_bf16 v[176:179], v[40:43], v[80:83], v[176:179]
    ds_read_b128 v[204:207], v4 offset:45056
    v_mfma_f32_16x16x32_bf16 v[192:195], v[40:43], v[246:249], v[192:195]
    ds_read_b128 v[208:211], v4 offset:47104
    s_getreg_b32 s50, hwreg(HW_REG_IB_STS, 0, 4)
    s_cmp_eq_u32 s50, 0
    s_cbranch_scc1 L_f1s25
    s_waitcnt lgkmcnt(3)
    v_mfma_f32_16x16x32_bf16 v[148:151], v[212:215], v[196:199], v[148:151]
    ds_read_b128 v[28:31], v5 offset:40960
    v_mfma_f32_16x16x32_bf16 v[164:167], v[196:199], v[216:219], v[164:167]
    ds_read_b64_tr_b16 v[76:77], v6 offset:28672
    v_mfma_f32_16x16x32_bf16 v[180:183], v[196:199], v[220:223], v[180:183]
    ds_read_b64_tr_b16 v[78:79], v6 offset:29184
    s_waitcnt lgkmcnt(5)
    v_mfma_f32_16x16x32_bf16 v[152:155], v[212:215], v[200:203], v[152:155]
    ds_read_b64_tr_b16 v[80:81], v6 offset:36864
    v_mfma_f32_16x16x32_bf16 v[168:171], v[200:203], v[216:219], v[168:171]
    ds_read_b64_tr_b16 v[82:83], v6 offset:37376
    v_mfma_f32_16x16x32_bf16 v[184:187], v[200:203], v[220:223], v[184:187]
    ds_read_b64_tr_b16 v[246:247], v6 offset:45056
    s_waitcnt lgkmcnt(7)
    v_mfma_f32_16x16x32_bf16 v[156:159], v[212:215], v[204:207], v[156:159]
    ds_read_b64_tr_b16 v[248:249], v6 offset:45568
    v_mfma_f32_16x16x32_bf16 v[172:175], v[204:207], v[216:219], v[172:175]
    ds_read_b128 v[32:35], v5 offset:43008
    v_mfma_f32_16x16x32_bf16 v[188:191], v[204:207], v[220:223], v[188:191]
    ds_read_b128 v[36:39], v5 offset:45056
    s_waitcnt lgkmcnt(9)
    v_mfma_f32_16x16x32_bf16 v[160:163], v[212:215], v[208:211], v[160:163]
    ds_read_b128 v[40:43], v5 offset:47104
    v_mfma_f32_16x16x32_bf16 v[176:179], v[208:211], v[216:219], v[176:179]
    v_mfma_f32_16x16x32_bf16 v[192:195], v[208:211], v[220:223], v[192:195]
    s_waitcnt vmcnt(0)
    s_mov_b64 exec, 1
    buffer_store_dword v251, v252, s[8:11], s60 offen sc1
    s_mov_b64 exec, -1
    s_branch L_c27
L_f1s18:
    s_waitcnt vmcnt(0)
    s_mov_b64 exec, 1
    buffer_store_dword v251, v252, s[8:11], s60 offen sc1
    s_mov_b64 exec, -1
    s_branch L_c19
L_f1s19:
    s_waitcnt vmcnt(0)
    s_mov_b64 exec, 1
    buffer_store_dword v251, v252, s[8:11], s60 offen sc1
    s_mov_b64 exec, -1
    s_branch L_c20
L_f1s20:
    s_waitcnt vmcnt(0)
    s_mov_b64 exec, 1
    buffer_store_dword v251, v252, s[8:11], s60 offen sc1
    s_mov_b64 exec, -1
    s_branch L_c21
L_f1s21:
    s_waitcnt vmcnt(0)
    s_mov_b64 exec, 1
    buffer_store_dword v251, v252, s[8:11], s60 offen sc1
    s_mov_b64 exec, -1
    s_branch L_c22
L_f1s22:
    s_waitcnt vmcnt(0)
    s_mov_b64 exec, 1
    buffer_store_dword v251, v252, s[8:11], s60 offen sc1
    s_mov_b64 exec, -1
    s_branch L_c23
L_f1s23:
    s_waitcnt vmcnt(0)
    s_mov_b64 exec, 1
    buffer_store_dword v251, v252, s[8:11], s60 offen sc1
    s_mov_b64 exec, -1
    s_branch L_c24
L_f1s24:
    s_waitcnt vmcnt(0)
    s_mov_b64 exec, 1
    buffer_store_dword v251, v252, s[8:11], s60 offen sc1
    s_mov_b64 exec, -1
    s_branch L_c25
L_f1s25:
    s_waitcnt vmcnt(0)
    s_mov_b64 exec, 1
    buffer_store_dword v251, v252, s[8:11], s60 offen sc1
    s_mov_b64 exec, -1
    s_branch L_c26
.p2align 5
L_c19:
    s_waitcnt lgkmcnt(3)
    v_mfma_f32_16x16x32_bf16 v[148:151], v[76:79], v[28:31], v[148:151]
    v_mfma_f32_16x16x32_bf16 v[164:167], v[28:31], v[80:83], v[164:167]
    s_waitcnt lgkmcnt(0)
    s_barrier
    v_mfma_f32_16x16x32_bf16 v[180:183], v[28:31], v[246:249], v[180:183]
    ds_read_b128 v[196:199], v4 offset:16384
    v_mfma_f32_16x16x32_bf16 v[152:155], v[76:79], v[32:35], v[152:155]
    ds_read_b64_tr_b16 v[212:213], v7 offset:0
    v_mfma_f32_16x16x32_bf16 v[168:171], v[32:35], v[80:83], v[168:171]
    ds_read_b64_tr_b16 v[214:215], v7 offset:512
    v_mfma_f32_16x16x32_bf16 v[184:187], v[32:35], v[246:249], v[184:187]
    ds_read_b64_tr_b16 v[216:217], v7 offset:8192
    v_mfma_f32_16x16x32_bf16 v[156:159], v[76:79], v[36:39], v[156:159]
    ds_read_b64_tr_b16 v[218:219], v7 offset:8704
    v_mfma_f32_16x16x32_bf16 v[172:175], v[36:39], v[80:83], v[172:175]
    ds_read_b64_tr_b16 v[220:221], v7 offset:16384
    v_mfma_f32_16x16x32_bf16 v[188:191], v[36:39], v[246:249], v[188:191]
    ds_read_b64_tr_b16 v[222:223], v7 offset:16896
    v_mfma_f32_16x16x32_bf16 v[160:163], v[76:79], v[40:43], v[160:163]
    ds_read_b128 v[200:203], v4 offset:18432
    v_mfma_f32_16x16x32_bf16 v[176:179], v[40:43], v[80:83], v[176:179]
    ds_read_b128 v[204:207], v4 offset:20480
    v_mfma_f32_16x16x32_bf16 v[192:195], v[40:43], v[246:249], v[192:195]
    ds_read_b128 v[208:211], v4 offset:22528
L_c20:
    s_waitcnt lgkmcnt(3)
    v_mfma_f32_16x16x32_bf16 v[148:151], v[212:215], v[196:199], v[148:151]
    ds_read_b128 v[28:31], v5 offset:16384
    v_mfma_f32_16x16x32_bf16 v[164:167], v[196:199], v[216:219], v[164:167]
    ds_read_b64_tr_b16 v[76:77], v7 offset:4096
    v_mfma_f32_16x16x32_bf16 v[180:183], v[196:199], v[220:223], v[180:183]
    ds_read_b64_tr_b16 v[78:79], v7 offset:4608
    s_waitcnt lgkmcnt(5)
    v_mfma_f32_16x16x32_bf16 v[152:155], v[212:215], v[200:203], v[152:155]
    ds_read_b64_tr_b16 v[80:81], v7 offset:12288
    v_mfma_f32_16x16x32_bf16 v[168:171], v[200:203], v[216:219], v[168:171]
    ds_read_b64_tr_b16 v[82:83], v7 offset:12800
    v_mfma_f32_16x16x32_bf16 v[184:187], v[200:203], v[220:223], v[184:187]
    ds_read_b64_tr_b16 v[246:247], v7 offset:20480
    s_waitcnt lgkmcnt(7)
    v_mfma_f32_16x16x32_bf16 v[156:159], v[212:215], v[204:207], v[156:159]
    ds_read_b64_tr_b16 v[248:249], v7 offset:20992
    v_mfma_f32_16x16x32_bf16 v[172:175], v[204:207], v[216:219], v[172:175]
    ds_read_b128 v[32:35], v5 offset:18432
    v_mfma_f32_16x16x32_bf16 v[188:191], v[204:207], v[220:223], v[188:191]
    ds_read_b128 v[36:39], v5 offset:20480
    s_waitcnt lgkmcnt(9)
    v_mfma_f32_16x16x32_bf16 v[160:163], v[212:215], v[208:211], v[160:163]
    ds_read_b128 v[40:43], v5 offset:22528
    v_mfma_f32_16x16x32_bf16 v[176:179], v[208:211], v[216:219], v[176:179]
    v_mfma_f32_16x16x32_bf16 v[192:195], v[208:211], v[220:223], v[192:195]
L_c21:
    s_waitcnt lgkmcnt(3)
    v_mfma_f32_16x16x32_bf16 v[148:151], v[76:79], v[28:31], v[148:151]
    v_mfma_f32_16x16x32_bf16 v[164:167], v[28:31], v[80:83], v[164:167]
    s_waitcnt lgkmcnt(0)
    s_barrier
    v_mfma_f32_16x16x32_bf16 v[180:183], v[28:31], v[246:249], v[180:183]
    ds_read_b128 v[196:199], v4 offset:24576
    v_mfma_f32_16x16x32_bf16 v[152:155], v[76:79], v[32:35], v[152:155]
    ds_read_b64_tr_b16 v[212:213], v7 offset:24576
    v_mfma_f32_16x16x32_bf16 v[168:171], v[32:35], v[80:83], v[168:171]
    ds_read_b64_tr_b16 v[214:215], v7 offset:25088
    v_mfma_f32_16x16x32_bf16 v[184:187], v[32:35], v[246:249], v[184:187]
    ds_read_b64_tr_b16 v[216:217], v7 offset:32768
    v_mfma_f32_16x16x32_bf16 v[156:159], v[76:79], v[36:39], v[156:159]
    ds_read_b64_tr_b16 v[218:219], v7 offset:33280
    v_mfma_f32_16x16x32_bf16 v[172:175], v[36:39], v[80:83], v[172:175]
    ds_read_b64_tr_b16 v[220:221], v7 offset:40960
    v_mfma_f32_16x16x32_bf16 v[188:191], v[36:39], v[246:249], v[188:191]
    ds_read_b64_tr_b16 v[222:223], v7 offset:41472
    v_mfma_f32_16x16x32_bf16 v[160:163], v[76:79], v[40:43], v[160:163]
    ds_read_b128 v[200:203], v4 offset:26624
    v_mfma_f32_16x16x32_bf16 v[176:179], v[40:43], v[80:83], v[176:179]
    ds_read_b128 v[204:207], v4 offset:28672
    v_mfma_f32_16x16x32_bf16 v[192:195], v[40:43], v[246:249], v[192:195]
    ds_read_b128 v[208:211], v4 offset:30720
L_c22:
    s_waitcnt lgkmcnt(3)
    v_mfma_f32_16x16x32_bf16 v[148:151], v[212:215], v[196:199], v[148:151]
    ds_read_b128 v[28:31], v5 offset:24576
    v_mfma_f32_16x16x32_bf16 v[164:167], v[196:199], v[216:219], v[164:167]
    ds_read_b64_tr_b16 v[76:77], v7 offset:28672
    v_mfma_f32_16x16x32_bf16 v[180:183], v[196:199], v[220:223], v[180:183]
    ds_read_b64_tr_b16 v[78:79], v7 offset:29184
    s_waitcnt lgkmcnt(5)
    v_mfma_f32_16x16x32_bf16 v[152:155], v[212:215], v[200:203], v[152:155]
    ds_read_b64_tr_b16 v[80:81], v7 offset:36864
    v_mfma_f32_16x16x32_bf16 v[168:171], v[200:203], v[216:219], v[168:171]
    ds_read_b64_tr_b16 v[82:83], v7 offset:37376
    v_mfma_f32_16x16x32_bf16 v[184:187], v[200:203], v[220:223], v[184:187]
    ds_read_b64_tr_b16 v[246:247], v7 offset:45056
    s_waitcnt lgkmcnt(7)
    v_mfma_f32_16x16x32_bf16 v[156:159], v[212:215], v[204:207], v[156:159]
    ds_read_b64_tr_b16 v[248:249], v7 offset:45568
    v_mfma_f32_16x16x32_bf16 v[172:175], v[204:207], v[216:219], v[172:175]
    ds_read_b128 v[32:35], v5 offset:26624
    v_mfma_f32_16x16x32_bf16 v[188:191], v[204:207], v[220:223], v[188:191]
    ds_read_b128 v[36:39], v5 offset:28672
    s_waitcnt lgkmcnt(9)
    v_mfma_f32_16x16x32_bf16 v[160:163], v[212:215], v[208:211], v[160:163]
    ds_read_b128 v[40:43], v5 offset:30720
    v_mfma_f32_16x16x32_bf16 v[176:179], v[208:211], v[216:219], v[176:179]
    v_mfma_f32_16x16x32_bf16 v[192:195], v[208:211], v[220:223], v[192:195]
L_c23:
    s_waitcnt lgkmcnt(3)
    v_mfma_f32_16x16x32_bf16 v[148:151], v[76:79], v[28:31], v[148:151]
    v_mfma_f32_16x16x32_bf16 v[164:167], v[28:31], v[80:83], v[164:167]
    s_waitcnt lgkmcnt(0)
    s_barrier
    v_mfma_f32_16x16x32_bf16 v[180:183], v[28:31], v[246:249], v[180:183]
    ds_read_b128 v[196:199], v4 offset:32768
    v_mfma_f32_16x16x32_bf16 v[152:155], v[76:79], v[32:35], v[152:155]
    ds_read_b64_tr_b16 v[212:213], v6 offset:0
    v_mfma_f32_16x16x32_bf16 v[168:171], v[32:35], v[80:83], v[168:171]
    ds_read_b64_tr_b16 v[214:215], v6 offset:512
    v_mfma_f32_16x16x32_bf16 v[184:187], v[32:35], v[246:249], v[184:187]
    ds_read_b64_tr_b16 v[216:217], v6 offset:8192
    v_mfma_f32_16x16x32_bf16 v[156:159], v[76:79], v[36:39], v[156:159]
    ds_read_b64_tr_b16 v[218:219], v6 offset:8704
    v_mfma_f32_16x16x32_bf16 v[172:175], v[36:39], v[80:83], v[172:175]
    ds_read_b64_tr_b16 v[220:221], v6 offset:16384
    v_mfma_f32_16x16x32_bf16 v[188:191], v[36:39], v[246:249], v[188:191]
    ds_read_b64_tr_b16 v[222:223], v6 offset:16896
    v_mfma_f32_16x16x32_bf16 v[160:163], v[76:79], v[40:43], v[160:163]
    ds_read_b128 v[200:203], v4 offset:34816
    v_mfma_f32_16x16x32_bf16 v[176:179], v[40:43], v[80:83], v[176:179]
    ds_read_b128 v[204:207], v4 offset:36864
    v_mfma_f32_16x16x32_bf16 v[192:195], v[40:43], v[246:249], v[192:195]
    ds_read_b128 v[208:211], v4 offset:38912
L_c24:
    s_waitcnt lgkmcnt(3)
    v_mfma_f32_16x16x32_bf16 v[148:151], v[212:215], v[196:199], v[148:151]
    ds_read_b128 v[28:31], v5 offset:32768
    v_mfma_f32_16x16x32_bf16 v[164:167], v[196:199], v[216:219], v[164:167]
    ds_read_b64_tr_b16 v[76:77], v6 offset:4096
    v_mfma_f32_16x16x32_bf16 v[180:183], v[196:199], v[220:223], v[180:183]
    ds_read_b64_tr_b16 v[78:79], v6 offset:4608
    s_waitcnt lgkmcnt(5)
    v_mfma_f32_16x16x32_bf16 v[152:155], v[212:215], v[200:203], v[152:155]
    ds_read_b64_tr_b16 v[80:81], v6 offset:12288
    v_mfma_f32_16x16x32_bf16 v[168:171], v[200:203], v[216:219], v[168:171]
    ds_read_b64_tr_b16 v[82:83], v6 offset:12800
    v_mfma_f32_16x16x32_bf16 v[184:187], v[200:203], v[220:223], v[184:187]
    ds_read_b64_tr_b16 v[246:247], v6 offset:20480
    s_waitcnt lgkmcnt(7)
    v_mfma_f32_16x16x32_bf16 v[156:159], v[212:215], v[204:207], v[156:159]
    ds_read_b64_tr_b16 v[248:249], v6 offset:20992
    v_mfma_f32_16x16x32_bf16 v[172:175], v[204:207], v[216:219], v[172:175]
    ds_read_b128 v[32:35], v5 offset:34816
    v_mfma_f32_16x16x32_bf16 v[188:191], v[204:207], v[220:223], v[188:191]
    ds_read_b128 v[36:39], v5 offset:36864
    s_waitcnt lgkmcnt(9)
    v_mfma_f32_16x16x32_bf16 v[160:163], v[212:215], v[208:211], v[160:163]
    ds_read_b128 v[40:43], v5 offset:38912
    v_mfma_f32_16x16x32_bf16 v[176:179], v[208:211], v[216:219], v[176:179]
    v_mfma_f32_16x16x32_bf16 v[192:195], v[208:211], v[220:223], v[192:195]
L_c25:
    s_waitcnt lgkmcnt(3)
    v_mfma_f32_16x16x32_bf16 v[148:151], v[76:79], v[28:31], v[148:151]
    v_mfma_f32_16x16x32_bf16 v[164:167], v[28:31], v[80:83], v[164:167]
    s_waitcnt lgkmcnt(0)
    s_barrier
    v_mfma_f32_16x16x32_bf16 v[180:183], v[28:31], v[246:249], v[180:183]
    ds_read_b128 v[196:199], v4 offset:40960
    v_mfma_f32_16x16x32_bf16 v[152:155], v[76:79], v[32:35], v[152:155]
    ds_read_b64_tr_b16 v[212:213], v6 offset:24576
    v_mfma_f32_16x16x32_bf16 v[168:171], v[32:35], v[80:83], v[168:171]
    ds_read_b64_tr_b16 v[214:215], v6 offset:25088
    v_mfma_f32_16x16x32_bf16 v[184:187], v[32:35], v[246:249], v[184:187]
    ds_read_b64_tr_b16 v[216:217], v6 offset:32768
    v_mfma_f32_16x16x32_bf16 v[156:159], v[76:79], v[36:39], v[156:159]
    ds_read_b64_tr_b16 v[218:219], v6 offset:33280
    v_mfma_f32_16x16x32_bf16 v[172:175], v[36:39], v[80:83], v[172:175]
    ds_read_b64_tr_b16 v[220:221], v6 offset:40960
    v_mfma_f32_16x16x32_bf16 v[188:191], v[36:39], v[246:249], v[188:191]
    ds_read_b64_tr_b16 v[222:223], v6 offset:41472
    v_mfma_f32_16x16x32_bf16 v[160:163], v[76:79], v[40:43], v[160:163]
    ds_read_b128 v[200:203], v4 offset:43008
    v_mfma_f32_16x16x32_bf16 v[176:179], v[40:43], v[80:83], v[176:179]
    ds_read_b128 v[204:207], v4 offset:45056
    v_mfma_f32_16x16x32_bf16 v[192:195], v[40:43], v[246:249], v[192:195]
    ds_read_b128 v[208:211], v4 offset:47104
L_c26:
    s_waitcnt lgkmcnt(3)
    v_mfma_f32_16x16x32_bf16 v[148:151], v[212:215], v[196:199], v[148:151]
    ds_read_b128 v[28:31], v5 offset:40960
    v_mfma_f32_16x16x32_bf16 v[164:167], v[196:199], v[216:219], v[164:167]
    ds_read_b64_tr_b16 v[76:77], v6 offset:28672
    v_mfma_f32_16x16x32_bf16 v[180:183], v[196:199], v[220:223], v[180:183]
    ds_read_b64_tr_b16 v[78:79], v6 offset:29184
    s_waitcnt lgkmcnt(5)
    v_mfma_f32_16x16x32_bf16 v[152:155], v[212:215], v[200:203], v[152:155]
    ds_read_b64_tr_b16 v[80:81], v6 offset:36864
    v_mfma_f32_16x16x32_bf16 v[168:171], v[200:203], v[216:219], v[168:171]
    ds_read_b64_tr_b16 v[82:83], v6 offset:37376
    v_mfma_f32_16x16x32_bf16 v[184:187], v[200:203], v[220:223], v[184:187]
    ds_read_b64_tr_b16 v[246:247], v6 offset:45056
    s_waitcnt lgkmcnt(7)
    v_mfma_f32_16x16x32_bf16 v[156:159], v[212:215], v[204:207], v[156:159]
    ds_read_b64_tr_b16 v[248:249], v6 offset:45568
    v_mfma_f32_16x16x32_bf16 v[172:175], v[204:207], v[216:219], v[172:175]
    ds_read_b128 v[32:35], v5 offset:43008
    v_mfma_f32_16x16x32_bf16 v[188:191], v[204:207], v[220:223], v[188:191]
    ds_read_b128 v[36:39], v5 offset:45056
    s_waitcnt lgkmcnt(9)
    v_mfma_f32_16x16x32_bf16 v[160:163], v[212:215], v[208:211], v[160:163]
    ds_read_b128 v[40:43], v5 offset:47104
    v_mfma_f32_16x16x32_bf16 v[176:179], v[208:211], v[216:219], v[176:179]
    v_mfma_f32_16x16x32_bf16 v[192:195], v[208:211], v[220:223], v[192:195]
L_c27:
    s_waitcnt lgkmcnt(3)
    v_mfma_f32_16x16x32_bf16 v[148:151], v[76:79], v[28:31], v[148:151]
    v_mfma_f32_16x16x32_bf16 v[164:167], v[28:31], v[80:83], v[164:167]
    s_waitcnt lgkmcnt(0)
    s_barrier
    v_mfma_f32_16x16x32_bf16 v[180:183], v[28:31], v[246:249], v[180:183]
    ds_read_b128 v[196:199], v4 offset:49152
    v_mfma_f32_16x16x32_bf16 v[152:155], v[76:79], v[32:35], v[152:155]
    ds_read_b64_tr_b16 v[212:213], v7 offset:0
    v_mfma_f32_16x16x32_bf16 v[168:171], v[32:35], v[80:83], v[168:171]
    ds_read_b64_tr_b16 v[214:215], v7 offset:512
    v_mfma_f32_16x16x32_bf16 v[184:187], v[32:35], v[246:249], v[184:187]
    ds_read_b64_tr_b16 v[216:217], v7 offset:8192
    v_mfma_f32_16x16x32_bf16 v[156:159], v[76:79], v[36:39], v[156:159]
    ds_read_b64_tr_b16 v[218:219], v7 offset:8704
    v_mfma_f32_16x16x32_bf16 v[172:175], v[36:39], v[80:83], v[172:175]
    ds_read_b64_tr_b16 v[220:221], v7 offset:16384
    v_mfma_f32_16x16x32_bf16 v[188:191], v[36:39], v[246:249], v[188:191]
    ds_read_b64_tr_b16 v[222:223], v7 offset:16896
    v_mfma_f32_16x16x32_bf16 v[160:163], v[76:79], v[40:43], v[160:163]
    ds_read_b128 v[200:203], v4 offset:51200
    v_mfma_f32_16x16x32_bf16 v[176:179], v[40:43], v[80:83], v[176:179]
    ds_read_b128 v[204:207], v4 offset:53248
    v_mfma_f32_16x16x32_bf16 v[192:195], v[40:43], v[246:249], v[192:195]
    ds_read_b128 v[208:211], v4 offset:55296
L_c28:
    s_waitcnt lgkmcnt(3)
    v_mfma_f32_16x16x32_bf16 v[148:151], v[212:215], v[196:199], v[148:151]
    ds_read_b128 v[28:31], v5 offset:49152
    v_mfma_f32_16x16x32_bf16 v[164:167], v[196:199], v[216:219], v[164:167]
    ds_read_b64_tr_b16 v[76:77], v7 offset:4096
    v_mfma_f32_16x16x32_bf16 v[180:183], v[196:199], v[220:223], v[180:183]
    ds_read_b64_tr_b16 v[78:79], v7 offset:4608
    s_waitcnt lgkmcnt(5)
    v_mfma_f32_16x16x32_bf16 v[152:155], v[212:215], v[200:203], v[152:155]
    ds_read_b64_tr_b16 v[80:81], v7 offset:12288
    v_mfma_f32_16x16x32_bf16 v[168:171], v[200:203], v[216:219], v[168:171]
    ds_read_b64_tr_b16 v[82:83], v7 offset:12800
    v_mfma_f32_16x16x32_bf16 v[184:187], v[200:203], v[220:223], v[184:187]
    ds_read_b64_tr_b16 v[246:247], v7 offset:20480
    s_waitcnt lgkmcnt(7)
    v_mfma_f32_16x16x32_bf16 v[156:159], v[212:215], v[204:207], v[156:159]
    ds_read_b64_tr_b16 v[248:249], v7 offset:20992
    v_mfma_f32_16x16x32_bf16 v[172:175], v[204:207], v[216:219], v[172:175]
    ds_read_b128 v[32:35], v5 offset:51200
    v_mfma_f32_16x16x32_bf16 v[188:191], v[204:207], v[220:223], v[188:191]
    ds_read_b128 v[36:39], v5 offset:53248
    s_waitcnt lgkmcnt(9)
    v_mfma_f32_16x16x32_bf16 v[160:163], v[212:215], v[208:211], v[160:163]
    ds_read_b128 v[40:43], v5 offset:55296
    v_mfma_f32_16x16x32_bf16 v[176:179], v[208:211], v[216:219], v[176:179]
    v_mfma_f32_16x16x32_bf16 v[192:195], v[208:211], v[220:223], v[192:195]
L_c29:
    s_waitcnt lgkmcnt(3)
    v_mfma_f32_16x16x32_bf16 v[148:151], v[76:79], v[28:31], v[148:151]
    v_mfma_f32_16x16x32_bf16 v[164:167], v[28:31], v[80:83], v[164:167]
    s_waitcnt lgkmcnt(0)
    s_barrier
    v_mfma_f32_16x16x32_bf16 v[180:183], v[28:31], v[246:249], v[180:183]
    ds_read_b128 v[196:199], v4 offset:57344
    v_mfma_f32_16x16x32_bf16 v[152:155], v[76:79], v[32:35], v[152:155]
    ds_read_b64_tr_b16 v[212:213], v7 offset:24576
    v_mfma_f32_16x16x32_bf16 v[168:171], v[32:35], v[80:83], v[168:171]
    ds_read_b64_tr_b16 v[214:215], v7 offset:25088
    v_mfma_f32_16x16x32_bf16 v[184:187], v[32:35], v[246:249], v[184:187]
    ds_read_b64_tr_b16 v[216:217], v7 offset:32768
    v_mfma_f32_16x16x32_bf16 v[156:159], v[76:79], v[36:39], v[156:159]
    ds_read_b64_tr_b16 v[218:219], v7 offset:33280
    v_mfma_f32_16x16x32_bf16 v[172:175], v[36:39], v[80:83], v[172:175]
    ds_read_b64_tr_b16 v[220:221], v7 offset:40960
    v_mfma_f32_16x16x32_bf16 v[188:191], v[36:39], v[246:249], v[188:191]
    ds_read_b64_tr_b16 v[222:223], v7 offset:41472
    v_mfma_f32_16x16x32_bf16 v[160:163], v[76:79], v[40:43], v[160:163]
    ds_read_b128 v[200:203], v4 offset:59392
    v_mfma_f32_16x16x32_bf16 v[176:179], v[40:43], v[80:83], v[176:179]
    ds_read_b128 v[204:207], v4 offset:61440
    v_mfma_f32_16x16x32_bf16 v[192:195], v[40:43], v[246:249], v[192:195]
    ds_read_b128 v[208:211], v4 offset:63488
L_c30:
    s_waitcnt lgkmcnt(3)
    v_mfma_f32_16x16x32_bf16 v[148:151], v[212:215], v[196:199], v[148:151]
    ds_read_b128 v[28:31], v5 offset:57344
    v_mfma_f32_16x16x32_bf16 v[164:167], v[196:199], v[216:219], v[164:167]
    ds_read_b64_tr_b16 v[76:77], v7 offset:28672
    v_mfma_f32_16x16x32_bf16 v[180:183], v[196:199], v[220:223], v[180:183]
    ds_read_b64_tr_b16 v[78:79], v7 offset:29184
    s_waitcnt lgkmcnt(5)
    v_mfma_f32_16x16x32_bf16 v[152:155], v[212:215], v[200:203], v[152:155]
    ds_read_b64_tr_b16 v[80:81], v7 offset:36864
    v_mfma_f32_16x16x32_bf16 v[168:171], v[200:203], v[216:219], v[168:171]
    ds_read_b64_tr_b16 v[82:83], v7 offset:37376
    v_mfma_f32_16x16x32_bf16 v[184:187], v[200:203], v[220:223], v[184:187]
    ds_read_b64_tr_b16 v[246:247], v7 offset:45056
    s_waitcnt lgkmcnt(7)
    v_mfma_f32_16x16x32_bf16 v[156:159], v[212:215], v[204:207], v[156:159]
    ds_read_b64_tr_b16 v[248:249], v7 offset:45568
    v_mfma_f32_16x16x32_bf16 v[172:175], v[204:207], v[216:219], v[172:175]
    ds_read_b128 v[32:35], v5 offset:59392
    v_mfma_f32_16x16x32_bf16 v[188:191], v[204:207], v[220:223], v[188:191]
    ds_read_b128 v[36:39], v5 offset:61440
    s_waitcnt lgkmcnt(9)
    v_mfma_f32_16x16x32_bf16 v[160:163], v[212:215], v[208:211], v[160:163]
    ds_read_b128 v[40:43], v5 offset:63488
    v_mfma_f32_16x16x32_bf16 v[176:179], v[208:211], v[216:219], v[176:179]
    v_mfma_f32_16x16x32_bf16 v[192:195], v[208:211], v[220:223], v[192:195]
L_c31:
    s_waitcnt lgkmcnt(3)
    v_mfma_f32_16x16x32_bf16 v[148:151], v[76:79], v[28:31], v[148:151]
    v_mfma_f32_16x16x32_bf16 v[164:167], v[28:31], v[80:83], v[164:167]
    s_waitcnt lgkmcnt(0)
    v_mfma_f32_16x16x32_bf16 v[180:183], v[28:31], v[246:249], v[180:183]
    v_mfma_f32_16x16x32_bf16 v[152:155], v[76:79], v[32:35], v[152:155]
    v_mfma_f32_16x16x32_bf16 v[168:171], v[32:35], v[80:83], v[168:171]
    v_mfma_f32_16x16x32_bf16 v[184:187], v[32:35], v[246:249], v[184:187]
    v_mfma_f32_16x16x32_bf16 v[156:159], v[76:79], v[36:39], v[156:159]
    v_mfma_f32_16x16x32_bf16 v[172:175], v[36:39], v[80:83], v[172:175]
    v_mfma_f32_16x16x32_bf16 v[188:191], v[36:39], v[246:249], v[188:191]
    v_mfma_f32_16x16x32_bf16 v[160:163], v[76:79], v[40:43], v[160:163]
    v_mfma_f32_16x16x32_bf16 v[176:179], v[40:43], v[80:83], v[176:179]
    v_mfma_f32_16x16x32_bf16 v[192:195], v[40:43], v[246:249], v[192:195]
    s_nop 5
    v_pk_mul_f32 v[196:197], v[164:165], s[52:53]
    v_pk_mul_f32 v[198:199], v[166:167], s[52:53]
    v_pk_mul_f32 v[200:201], v[168:169], s[52:53]
    v_pk_mul_f32 v[202:203], v[170:171], s[52:53]
    v_pk_mul_f32 v[204:205], v[172:173], s[52:53]
    v_pk_mul_f32 v[206:207], v[174:175], s[52:53]
    v_pk_mul_f32 v[208:209], v[176:177], s[52:53]
    v_pk_mul_f32 v[210:211], v[178:179], s[52:53]
    v_exp_f32_e64 v196, v196 clamp
    v_exp_f32_e64 v197, v197 clamp
    v_exp_f32_e64 v198, v198 clamp
    v_exp_f32_e64 v199, v199 clamp
    v_exp_f32_e64 v200, v200 clamp
    v_exp_f32_e64 v201, v201 clamp
    v_exp_f32_e64 v202, v202 clamp
    v_exp_f32_e64 v203, v203 clamp
    v_exp_f32_e64 v204, v204 clamp
    v_exp_f32_e64 v205, v205 clamp
    v_exp_f32_e64 v206, v206 clamp
    v_exp_f32_e64 v207, v207 clamp
    v_exp_f32_e64 v208, v208 clamp
    v_exp_f32_e64 v209, v209 clamp
    v_exp_f32_e64 v210, v210 clamp
    v_exp_f32_e64 v211, v211 clamp
    v_max_f32 v164, 0, v164
    v_max_f32 v165, 0, v165
    v_max_f32 v166, 0, v166
    v_max_f32 v167, 0, v167
    v_max_f32 v168, 0, v168
    v_max_f32 v169, 0, v169
    v_max_f32 v170, 0, v170
    v_max_f32 v171, 0, v171
    v_max_f32 v172, 0, v172
    v_max_f32 v173, 0, v173
    v_max_f32 v174, 0, v174
    v_max_f32 v175, 0, v175
    v_max_f32 v176, 0, v176
    v_max_f32 v177, 0, v177
    v_max_f32 v178, 0, v178
    v_max_f32 v179, 0, v179
    v_pk_add_f32 v[196:197], v[196:197], s[54:55]
    v_pk_add_f32 v[198:199], v[198:199], s[54:55]
    v_pk_add_f32 v[200:201], v[200:201], s[54:55]
    v_pk_add_f32 v[202:203], v[202:203], s[54:55]
    v_pk_add_f32 v[204:205], v[204:205], s[54:55]
    v_pk_add_f32 v[206:207], v[206:207], s[54:55]
    v_pk_add_f32 v[208:209], v[208:209], s[54:55]
    v_pk_add_f32 v[210:211], v[210:211], s[54:55]
    v_pk_add_f32 v[164:165], v[164:165], v[196:197]
    v_pk_add_f32 v[166:167], v[166:167], v[198:199]
    v_pk_add_f32 v[168:169], v[168:169], v[200:201]
    v_pk_add_f32 v[170:171], v[170:171], v[202:203]
    v_pk_add_f32 v[172:173], v[172:173], v[204:205]
    v_pk_add_f32 v[174:175], v[174:175], v[206:207]
    v_pk_add_f32 v[176:177], v[176:177], v[208:209]
    v_pk_add_f32 v[178:179], v[178:179], v[210:211]
    v_cvt_pk_bf16_f32 v180, v180, v181
    v_cvt_pk_bf16_f32 v181, v182, v183
    v_cvt_pk_bf16_f32 v182, v184, v185
    v_cvt_pk_bf16_f32 v183, v186, v187
    v_cvt_pk_bf16_f32 v188, v188, v189
    v_cvt_pk_bf16_f32 v189, v190, v191
    v_cvt_pk_bf16_f32 v190, v192, v193
    v_cvt_pk_bf16_f32 v191, v194, v195
    v_cvt_pk_bf16_f32 v164, v164, v165
    v_cvt_pk_bf16_f32 v165, v166, v167
    v_cvt_pk_bf16_f32 v166, v168, v169
    v_cvt_pk_bf16_f32 v167, v170, v171
    v_cvt_pk_bf16_f32 v172, v172, v173
    v_cvt_pk_bf16_f32 v173, v174, v175
    v_cvt_pk_bf16_f32 v174, v176, v177
    v_cvt_pk_bf16_f32 v175, v178, v179
    s_nop 0
    v_mfma_f32_16x16x32_bf16 v[16:19], v[164:167], v[180:183], 0
    v_mfma_f32_16x16x32_bf16 v[20:23], v[164:167], v[24:27], 0
    v_mfma_f32_16x16x32_bf16 v[16:19], v[172:175], v[188:191], v[16:19]
    v_mfma_f32_16x16x32_bf16 v[20:23], v[172:175], v[24:27], v[20:23]
    v_pk_mul_f32 v[196:197], v[148:149], s[52:53]
    v_pk_mul_f32 v[198:199], v[150:151], s[52:53]
    v_pk_mul_f32 v[200:201], v[152:153], s[52:53]
    v_pk_mul_f32 v[202:203], v[154:155], s[52:53]
    v_pk_mul_f32 v[204:205], v[156:157], s[52:53]
    v_pk_mul_f32 v[206:207], v[158:159], s[52:53]
    v_pk_mul_f32 v[208:209], v[160:161], s[52:53]
    v_pk_mul_f32 v[210:211], v[162:163], s[52:53]
    v_exp_f32_e64 v196, v196 clamp
    v_exp_f32_e64 v197, v197 clamp
    v_exp_f32_e64 v198, v198 clamp
    v_exp_f32_e64 v199, v199 clamp
    v_exp_f32_e64 v200, v200 clamp
    v_exp_f32_e64 v201, v201 clamp
    v_exp_f32_e64 v202, v202 clamp
    v_exp_f32_e64 v203, v203 clamp
    v_exp_f32_e64 v204, v204 clamp
    v_exp_f32_e64 v205, v205 clamp
    v_exp_f32_e64 v206, v206 clamp
    v_exp_f32_e64 v207, v207 clamp
    v_exp_f32_e64 v208, v208 clamp
    v_exp_f32_e64 v209, v209 clamp
    v_exp_f32_e64 v210, v210 clamp
    v_exp_f32_e64 v211, v211 clamp
    v_max_f32 v148, 0, v148
    v_max_f32 v149, 0, v149
    v_max_f32 v150, 0, v150
    v_max_f32 v151, 0, v151
    v_max_f32 v152, 0, v152
    v_max_f32 v153, 0, v153
    v_max_f32 v154, 0, v154
    v_max_f32 v155, 0, v155
    v_max_f32 v156, 0, v156
    v_max_f32 v157, 0, v157
    v_max_f32 v158, 0, v158
    v_max_f32 v159, 0, v159
    v_max_f32 v160, 0, v160
    v_max_f32 v161, 0, v161
    v_max_f32 v162, 0, v162
    v_max_f32 v163, 0, v163
    v_pk_add_f32 v[196:197], v[196:197], s[54:55]
    v_pk_add_f32 v[198:199], v[198:199], s[54:55]
    v_pk_add_f32 v[200:201], v[200:201], s[54:55]
    v_pk_add_f32 v[202:203], v[202:203], s[54:55]
    v_pk_add_f32 v[204:205], v[204:205], s[54:55]
    v_pk_add_f32 v[206:207], v[206:207], s[54:55]
    v_pk_add_f32 v[208:209], v[208:209], s[54:55]
    v_pk_add_f32 v[210:211], v[210:211], s[54:55]
    v_pk_add_f32 v[148:149], v[148:149], v[196:197]
    v_pk_add_f32 v[150:151], v[150:151], v[198:199]
    v_pk_add_f32 v[152:153], v[152:153], v[200:201]
    v_pk_add_f32 v[154:155], v[154:155], v[202:203]
    v_pk_add_f32 v[156:157], v[156:157], v[204:205]
    v_pk_add_f32 v[158:159], v[158:159], v[206:207]
    v_pk_add_f32 v[160:161], v[160:161], v[208:209]
    v_pk_add_f32 v[162:163], v[162:163], v[210:211]
    v_cvt_pk_bf16_f32 v148, v148, v149
    v_cvt_pk_bf16_f32 v149, v150, v151
    v_cvt_pk_bf16_f32 v150, v152, v153
    v_cvt_pk_bf16_f32 v151, v154, v155
    s_nop 0
    v_permlane16_swap_b32 v148, v150
    v_permlane16_swap_b32 v149, v151
    buffer_store_dwordx4 v[148:151], v2, s[8:11], s64 offen offset:0 sc1
    v_cvt_pk_bf16_f32 v156, v156, v157
    v_cvt_pk_bf16_f32 v157, v158, v159
    v_cvt_pk_bf16_f32 v158, v160, v161
    v_cvt_pk_bf16_f32 v159, v162, v163
    s_nop 0
    v_permlane16_swap_b32 v156, v158
    v_permlane16_swap_b32 v157, v159
    buffer_store_dwordx4 v[156:159], v2, s[8:11], s64 offen offset:1024 sc1
    buffer_store_dwordx4 v[16:19], v8, s[8:11], s65 offen sc1
    s_mov_b32 exec_lo, 0x00010001
    s_mov_b32 exec_hi, 0x00010001
    buffer_store_dwordx4 v[20:23], v10, s[8:11], s65 offen offset:1024 sc1
    s_mov_b64 exec, -1
    s_branch L_attn
.p2align 5
    s_nop 0
L_attn:
    v_xor_b32 v110, 0x400, v228
    s_barrier
    s_cmp_lt_u32 s44, 4
    s_cbranch_scc1 L_noprio
    s_setprio 1
L_noprio:
    ds_read_b128 v[36:39], v110
    ds_read_b128 v[76:79], v226 offset:0
    ds_read_b128 v[40:43], v228
    ds_read_b128 v[80:83], v226 offset:1024
    s_mov_b64 exec, s[56:57]
    ds_read_b128 v[84:87], v227 offset:0
    ds_read_b128 v[88:91], v227 offset:512
    s_mov_b64 exec, -1
    s_waitcnt lgkmcnt(4)
    v_mfma_f32_32x32x16_bf16 v[4:19], v[76:79], v[36:39], 0
    s_nop 10
    s_waitcnt lgkmcnt(0)
    s_add_u32 m0, s73, 32768
    s_add_u32 s50, s72, 8192
    buffer_load_dwordx4 v2, s[8:11], s50 offen offset:0 sc1 lds
    buffer_load_dwordx4 v2, s[8:11], s50 offen offset:1024 sc1 lds
    v_exp_f32 v4, v4
    v_exp_f32 v5, v5
    s_mov_b64 exec, s[56:57]
    ds_read_b128 v[92:95], v227 offset:1024
    ds_read_b128 v[96:99], v227 offset:1536
    s_mov_b64 exec, -1
    v_exp_f32 v6, v6
    v_exp_f32 v7, v7
    v_exp_f32 v8, v8
    v_mfma_f32_32x32x16_bf16 v[20:35], v[76:79], v[40:43], 0
    ds_read_b128 v[76:79], v226 offset:2048
    v_exp_f32 v9, v9
    v_exp_f32 v10, v10
    v_exp_f32 v11, v11
    v_exp_f32 v12, v12
    v_exp_f32 v13, v13
    v_smfmac_f32_32x32x32_bf16 v[44:59], v[84:87], v[4:11], v3
    v_exp_f32 v14, v14
    v_exp_f32 v15, v15
    v_exp_f32 v16, v16
    v_exp_f32 v17, v17
    v_exp_f32 v18, v18
    v_exp_f32 v19, v19
    s_add_u32 m0, s73, 49152
    s_add_u32 s50, s72, 12288
    buffer_load_dwordx4 v2, s[8:11], s50 offen offset:0 sc1 lds
    buffer_load_dwordx4 v2, s[8:11], s50 offen offset:1024 sc1 lds
    v_exp_f32 v20, v20
    v_exp_f32 v21, v21
    v_smfmac_f32_32x32x32_bf16 v[44:59], v[88:91], v[12:19], v3
    v_exp_f32 v22, v22
    v_exp_f32 v23, v23
    v_exp_f32 v24, v24
    s_waitcnt lgkmcnt(0)
    v_mfma_f32_32x32x16_bf16 v[4:19], v[80:83], v[36:39], 0
    v_exp_f32 v25, v25
    v_exp_f32 v26, v26
    v_exp_f32 v27, v27
    v_exp_f32 v28, v28
    v_exp_f32 v29, v29
    v_smfmac_f32_32x32x32_bf16 v[60:75], v[84:87], v[20:27], v3
    v_exp_f32 v30, v30
    v_exp_f32 v31, v31
    v_exp_f32 v32, v32
    v_exp_f32 v33, v33
    v_exp_f32 v34, v34
    v_exp_f32 v35, v35
    v_exp_f32 v4, v4
    v_exp_f32 v5, v5
    v_smfmac_f32_32x32x32_bf16 v[60:75], v[88:91], v[28:35], v3
    s_mov_b64 exec, s[56:57]
    ds_read_b128 v[84:87], v227 offset:2048
    ds_read_b128 v[88:91], v227 offset:2560
    s_mov_b64 exec, -1
    v_exp_f32 v6, v6
    v_exp_f32 v7, v7
    v_exp_f32 v8, v8
    v_mfma_f32_32x32x16_bf16 v[20:35], v[80:83], v[40:43], 0
    ds_read_b128 v[80:83], v226 offset:3072
    v_exp_f32 v9, v9
    v_exp_f32 v10, v10
    v_exp_f32 v11, v11
    v_exp_f32 v12, v12
    v_exp_f32 v13, v13
    v_smfmac_f32_32x32x32_bf16 v[44:59], v[92:95], v[4:11], v3
    v_exp_f32 v14, v14
    v_exp_f32 v15, v15
    v_exp_f32 v16, v16
    v_exp_f32 v17, v17
    v_exp_f32 v18, v18
    v_exp_f32 v19, v19
    v_exp_f32 v20, v20
    v_exp_f32 v21, v21
    v_smfmac_f32_32x32x32_bf16 v[44:59], v[96:99], v[12:19], v3
    v_exp_f32 v22, v22
    v_exp_f32 v23, v23
    v_exp_f32 v24, v24
    s_waitcnt lgkmcnt(0)
    v_mfma_f32_32x32x16_bf16 v[4:19], v[76:79], v[36:39], 0
    v_exp_f32 v25, v25
    v_exp_f32 v26, v26
    v_exp_f32 v27, v27
    v_exp_f32 v28, v28
    v_exp_f32 v29, v29
    v_smfmac_f32_32x32x32_bf16 v[60:75], v[92:95], v[20:27], v3
    v_exp_f32 v30, v30
    v_exp_f32 v31, v31
    v_exp_f32 v32, v32
    v_exp_f32 v33, v33
    v_exp_f32 v34, v34
    v_exp_f32 v35, v35
    s_waitcnt vmcnt(4)
    s_barrier
    s_add_u32 m0, s73, 65536
    s_add_u32 s50, s72, 16384
    buffer_load_dwordx4 v2, s[8:11], s50 offen offset:0 sc1 lds
    buffer_load_dwordx4 v2, s[8:11], s50 offen offset:1024 sc1 lds
    v_exp_f32 v4, v4
    v_exp_f32 v5, v5
    v_smfmac_f32_32x32x32_bf16 v[60:75], v[96:99], v[28:35], v3
    s_mov_b64 exec, s[56:57]
    ds_read_b128 v[92:95], v227 offset:3072
    ds_read_b128 v[96:99], v227 offset:3584
    s_mov_b64 exec, -1
    v_exp_f32 v6, v6
    v_exp_f32 v7, v7
    v_exp_f32 v8, v8
    v_mfma_f32_32x32x16_bf16 v[20:35], v[76:79], v[40:43], 0
    ds_read_b128 v[76:79], v226 offset:16384
    v_exp_f32 v9, v9
    v_exp_f32 v10, v10
    v_exp_f32 v11, v11
    v_exp_f32 v12, v12
    v_exp_f32 v13, v13
    v_smfmac_f32_32x32x32_bf16 v[44:59], v[84:87], v[4:11], v3
    v_exp_f32 v14, v14
    v_exp_f32 v15, v15
    v_exp_f32 v16, v16
    v_exp_f32 v17, v17
    v_exp_f32 v18, v18
    v_exp_f32 v19, v19
    s_add_u32 m0, s73, 81920
    s_add_u32 s50, s72, 20480
    buffer_load_dwordx4 v2, s[8:11], s50 offen offset:0 sc1 lds
    buffer_load_dwordx4 v2, s[8:11], s50 offen offset:1024 sc1 lds
    v_exp_f32 v20, v20
    v_exp_f32 v21, v21
    v_smfmac_f32_32x32x32_bf16 v[44:59], v[88:91], v[12:19], v3
    v_exp_f32 v22, v22
    v_exp_f32 v23, v23
    v_exp_f32 v24, v24
    s_waitcnt lgkmcnt(0)
    v_mfma_f32_32x32x16_bf16 v[4:19], v[80:83], v[36:39], 0
    v_exp_f32 v25, v25
    v_exp_f32 v26, v26
    v_exp_f32 v27, v27
    v_exp_f32 v28, v28
    v_exp_f32 v29, v29
    v_smfmac_f32_32x32x32_bf16 v[60:75], v[84:87], v[20:27], v3
    v_exp_f32 v30, v30
    v_exp_f32 v31, v31
    v_exp_f32 v32, v32
    v_exp_f32 v33, v33
    v_exp_f32 v34, v34
    v_exp_f32 v35, v35
    s_add_u32 m0, s73, 98304
    s_add_u32 s50, s72, 24576
    buffer_load_dwordx4 v2, s[8:11], s50 offen offset:0 sc1 lds
    buffer_load_dwordx4 v2, s[8:11], s50 offen offset:1024 sc1 lds
    v_exp_f32 v4, v4
    v_exp_f32 v5, v5
    v_smfmac_f32_32x32x32_bf16 v[60:75], v[88:91], v[28:35], v3
    s_mov_b64 exec, s[56:57]
    ds_read_b128 v[84:87], v227 offset:16384
    ds_read_b128 v[88:91], v227 offset:16896
    s_mov_b64 exec, -1
    v_exp_f32 v6, v6
    v_exp_f32 v7, v7
    v_exp_f32 v8, v8
    v_mfma_f32_32x32x16_bf16 v[20:35], v[80:83], v[40:43], 0
    ds_read_b128 v[80:83], v226 offset:17408
    v_exp_f32 v9, v9
    v_exp_f32 v10, v10
    v_exp_f32 v11, v11
    v_exp_f32 v12, v12
    v_exp_f32 v13, v13
    v_smfmac_f32_32x32x32_bf16 v[44:59], v[92:95], v[4:11], v3
    v_exp_f32 v14, v14
    v_exp_f32 v15, v15
    v_exp_f32 v16, v16
    v_exp_f32 v17, v17
    v_exp_f32 v18, v18
    v_exp_f32 v19, v19
    s_add_u32 m0, s73, 114688
    s_add_u32 s50, s72, 28672
    buffer_load_dwordx4 v2, s[8:11], s50 offen offset:0 sc1 lds
    buffer_load_dwordx4 v2, s[8:11], s50 offen offset:1024 sc1 lds
    v_exp_f32 v20, v20
    v_exp_f32 v21, v21
    v_smfmac_f32_32x32x32_bf16 v[44:59], v[96:99], v[12:19], v3
    v_exp_f32 v22, v22
    v_exp_f32 v23, v23
    v_exp_f32 v24, v24
    s_waitcnt lgkmcnt(0)
    v_mfma_f32_32x32x16_bf16 v[4:19], v[76:79], v[36:39], 0
    v_exp_f32 v25, v25
    v_exp_f32 v26, v26
    v_exp_f32 v27, v27
    v_exp_f32 v28, v28
    v_exp_f32 v29, v29
    v_smfmac_f32_32x32x32_bf16 v[60:75], v[92:95], v[20:27], v3
    v_exp_f32 v30, v30
    v_exp_f32 v31, v31
    v_exp_f32 v32, v32
    v_exp_f32 v33, v33
    v_exp_f32 v34, v34
    v_exp_f32 v35, v35
    v_exp_f32 v4, v4
    v_exp_f32 v5, v5
    v_smfmac_f32_32x32x32_bf16 v[60:75], v[96:99], v[28:35], v3
    s_mov_b64 exec, s[56:57]
    ds_read_b128 v[92:95], v227 offset:17408
    ds_read_b128 v[96:99], v227 offset:17920
    s_mov_b64 exec, -1
    v_exp_f32 v6, v6
    v_exp_f32 v7, v7
    v_exp_f32 v8, v8
    v_mfma_f32_32x32x16_bf16 v[20:35], v[76:79], v[40:43], 0
    ds_read_b128 v[76:79], v226 offset:18432
    v_exp_f32 v9, v9
    v_exp_f32 v10, v10
    v_exp_f32 v11, v11
    v_exp_f32 v12, v12
    v_exp_f32 v13, v13
    v_smfmac_f32_32x32x32_bf16 v[44:59], v[84:87], v[4:11], v3
    v_exp_f32 v14, v14
    v_exp_f32 v15, v15
    v_exp_f32 v16, v16
    v_exp_f32 v17, v17
    v_exp_f32 v18, v18
    v_exp_f32 v19, v19
    v_exp_f32 v20, v20
    v_exp_f32 v21, v21
    v_smfmac_f32_32x32x32_bf16 v[44:59], v[88:91], v[12:19], v3
    v_exp_f32 v22, v22
    v_exp_f32 v23, v23
    v_exp_f32 v24, v24
    s_waitcnt lgkmcnt(0)
    v_mfma_f32_32x32x16_bf16 v[4:19], v[80:83], v[36:39], 0
    v_exp_f32 v25, v25
    v_exp_f32 v26, v26
    v_exp_f32 v27, v27
    v_exp_f32 v28, v28
    v_exp_f32 v29, v29
    v_smfmac_f32_32x32x32_bf16 v[60:75], v[84:87], v[20:27], v3
    v_exp_f32 v30, v30
    v_exp_f32 v31, v31
    v_exp_f32 v32, v32
    v_exp_f32 v33, v33
    v_exp_f32 v34, v34
    v_exp_f32 v35, v35
    v_exp_f32 v4, v4
    v_exp_f32 v5, v5
    v_smfmac_f32_32x32x32_bf16 v[60:75], v[88:91], v[28:35], v3
    s_mov_b64 exec, s[56:57]
    ds_read_b128 v[84:87], v227 offset:18432
    ds_read_b128 v[88:91], v227 offset:18944
    s_mov_b64 exec, -1
    v_exp_f32 v6, v6
    v_exp_f32 v7, v7
    v_exp_f32 v8, v8
    v_mfma_f32_32x32x16_bf16 v[20:35], v[80:83], v[40:43], 0
    ds_read_b128 v[80:83], v226 offset:19456
    v_exp_f32 v9, v9
    v_exp_f32 v10, v10
    v_exp_f32 v11, v11
    v_exp_f32 v12, v12
    v_exp_f32 v13, v13
    v_smfmac_f32_32x32x32_bf16 v[44:59], v[92:95], v[4:11], v3
    v_exp_f32 v14, v14
    v_exp_f32 v15, v15
    v_exp_f32 v16, v16
    v_exp_f32 v17, v17
    v_exp_f32 v18, v18
    v_exp_f32 v19, v19
    v_exp_f32 v20, v20
    v_exp_f32 v21, v21
    v_smfmac_f32_32x32x32_bf16 v[44:59], v[96:99], v[12:19], v3
    v_exp_f32 v22, v22
    v_exp_f32 v23, v23
    v_exp_f32 v24, v24
    s_waitcnt lgkmcnt(0)
    v_mfma_f32_32x32x16_bf16 v[4:19], v[76:79], v[36:39], 0
    v_exp_f32 v25, v25
    v_exp_f32 v26, v26
    v_exp_f32 v27, v27
    v_exp_f32 v28, v28
    v_exp_f32 v29, v29
    v_smfmac_f32_32x32x32_bf16 v[60:75], v[92:95], v[20:27], v3
    v_exp_f32 v30, v30
    v_exp_f32 v31, v31
    v_exp_f32 v32, v32
    v_exp_f32 v33, v33
    v_exp_f32 v34, v34
    v_exp_f32 v35, v35
    s_waitcnt vmcnt(8)
    s_barrier
    s_cmp_lg_u32 s44, 0
    s_cbranch_scc1 L_nof2
    s_mov_b64 exec, 1
    buffer_store_dword v251, v252, s[8:11], s74 offen sc1
    s_mov_b64 exec, -1
L_nof2:
    v_exp_f32 v4, v4
    v_exp_f32 v5, v5
    v_smfmac_f32_32x32x32_bf16 v[60:75], v[96:99], v[28:35], v3
    s_mov_b64 exec, s[56:57]
    ds_read_b128 v[92:95], v227 offset:19456
    ds_read_b128 v[96:99], v227 offset:19968
    s_mov_b64 exec, -1
    v_exp_f32 v6, v6
    v_exp_f32 v7, v7
    v_exp_f32 v8, v8
    v_mfma_f32_32x32x16_bf16 v[20:35], v[76:79], v[40:43], 0
    ds_read_b128 v[76:79], v226 offset:32768
    v_exp_f32 v9, v9
    v_exp_f32 v10, v10
    v_exp_f32 v11, v11
    v_exp_f32 v12, v12
    v_exp_f32 v13, v13
    v_smfmac_f32_32x32x32_bf16 v[44:59], v[84:87], v[4:11], v3
    v_exp_f32 v14, v14
    v_exp_f32 v15, v15
    v_exp_f32 v16, v16
    v_exp_f32 v17, v17
    v_exp_f32 v18, v18
    v_exp_f32 v19, v19
    v_mov_b32 v144, -1
    v_mov_b32 v145, -1
    v_mov_b32 v146, -1
    v_mov_b32 v147, -1
    buffer_store_dwordx4 v[144:147], v2, s[8:11], s80 offen sc1
    v_exp_f32 v20, v20
    v_exp_f32 v21, v21
    v_smfmac_f32_32x32x32_bf16 v[44:59], v[88:91], v[12:19], v3
    v_exp_f32 v22, v22
    v_exp_f32 v23, v23
    v_exp_f32 v24, v24
    s_waitcnt lgkmcnt(0)
    v_mfma_f32_32x32x16_bf16 v[4:19], v[80:83], v[36:39], 0
    v_exp_f32 v25, v25
    v_exp_f32 v26, v26
    v_exp_f32 v27, v27
    v_exp_f32 v28, v28
    v_exp_f32 v29, v29
    v_smfmac_f32_32x32x32_bf16 v[60:75], v[84:87], v[20:27], v3
    v_exp_f32 v30, v30
    v_exp_f32 v31, v31
    v_exp_f32 v32, v32
    v_exp_f32 v33, v33
    v_exp_f32 v34, v34
    v_exp_f32 v35, v35
    v_exp_f32 v4, v4
    v_exp_f32 v5, v5
    v_smfmac_f32_32x32x32_bf16 v[60:75], v[88:91], v[28:35], v3
    s_mov_b64 exec, s[56:57]
    ds_read_b128 v[84:87], v227 offset:32768
    ds_read_b128 v[88:91], v227 offset:33280
    s_mov_b64 exec, -1
    v_exp_f32 v6, v6
    v_exp_f32 v7, v7
    v_exp_f32 v8, v8
    v_mfma_f32_32x32x16_bf16 v[20:35], v[80:83], v[40:43], 0
    ds_read_b128 v[80:83], v226 offset:33792
    v_exp_f32 v9, v9
    v_exp_f32 v10, v10
    v_exp_f32 v11, v11
    v_exp_f32 v12, v12
    v_exp_f32 v13, v13
    v_smfmac_f32_32x32x32_bf16 v[44:59], v[92:95], v[4:11], v3
    v_exp_f32 v14, v14
    v_exp_f32 v15, v15
    v_exp_f32 v16, v16
    v_exp_f32 v17, v17
    v_exp_f32 v18, v18
    v_exp_f32 v19, v19
    v_exp_f32 v20, v20
    v_exp_f32 v21, v21
    v_smfmac_f32_32x32x32_bf16 v[44:59], v[96:99], v[12:19], v3
    v_exp_f32 v22, v22
    v_exp_f32 v23, v23
    v_exp_f32 v24, v24
    s_waitcnt lgkmcnt(0)
    v_mfma_f32_32x32x16_bf16 v[4:19], v[76:79], v[36:39], 0
    v_exp_f32 v25, v25
    v_exp_f32 v26, v26
    v_exp_f32 v27, v27
    v_exp_f32 v28, v28
    v_exp_f32 v29, v29
    v_smfmac_f32_32x32x32_bf16 v[60:75], v[92:95], v[20:27], v3
    v_exp_f32 v30, v30
    v_exp_f32 v31, v31
    v_exp_f32 v32, v32
    v_exp_f32 v33, v33
    v_exp_f32 v34, v34
    v_exp_f32 v35, v35
    v_exp_f32 v4, v4
    v_exp_f32 v5, v5
    v_smfmac_f32_32x32x32_bf16 v[60:75], v[96:99], v[28:35], v3
    s_mov_b64 exec, s[56:57]
    ds_read_b128 v[92:95], v227 offset:33792
    ds_read_b128 v[96:99], v227 offset:34304
    s_mov_b64 exec, -1
    v_exp_f32 v6, v6
    v_exp_f32 v7, v7
    v_exp_f32 v8, v8
    v_mfma_f32_32x32x16_bf16 v[20:35], v[76:79], v[40:43], 0
    ds_read_b128 v[76:79], v226 offset:34816
    v_exp_f32 v9, v9
    v_exp_f32 v10, v10
    v_exp_f32 v11, v11
    v_exp_f32 v12, v12
    v_exp_f32 v13, v13
    v_smfmac_f32_32x32x32_bf16 v[44:59], v[84:87], v[4:11], v3
    v_exp_f32 v14, v14
    v_exp_f32 v15, v15
    v_exp_f32 v16, v16
    v_exp_f32 v17, v17
    v_exp_f32 v18, v18
    v_exp_f32 v19, v19
    v_exp_f32 v20, v20
    v_exp_f32 v21, v21
    v_smfmac_f32_32x32x32_bf16 v[44:59], v[88:91], v[12:19], v3
    v_exp_f32 v22, v22
    v_exp_f32 v23, v23
    v_exp_f32 v24, v24
    s_waitcnt lgkmcnt(0)
    v_mfma_f32_32x32x16_bf16 v[4:19], v[80:83], v[36:39], 0
    v_exp_f32 v25, v25
    v_exp_f32 v26, v26
    v_exp_f32 v27, v27
    v_exp_f32 v28, v28
    v_exp_f32 v29, v29
    v_smfmac_f32_32x32x32_bf16 v[60:75], v[84:87], v[20:27], v3
    v_exp_f32 v30, v30
    v_exp_f32 v31, v31
    v_exp_f32 v32, v32
    v_exp_f32 v33, v33
    v_exp_f32 v34, v34
    v_exp_f32 v35, v35
    buffer_load_dword v103, v230, s[8:11], s75 offen sc1
    v_exp_f32 v4, v4
    v_exp_f32 v5, v5
    v_smfmac_f32_32x32x32_bf16 v[60:75], v[88:91], v[28:35], v3
    s_mov_b64 exec, s[56:57]
    ds_read_b128 v[84:87], v227 offset:34816
    ds_read_b128 v[88:91], v227 offset:35328
    s_mov_b64 exec, -1
    v_exp_f32 v6, v6
    v_exp_f32 v7, v7
    v_exp_f32 v8, v8
    v_mfma_f32_32x32x16_bf16 v[20:35], v[80:83], v[40:43], 0
    ds_read_b128 v[80:83], v226 offset:35840
    v_exp_f32 v9, v9
    v_exp_f32 v10, v10
    v_exp_f32 v11, v11
    v_exp_f32 v12, v12
    v_exp_f32 v13, v13
    v_smfmac_f32_32x32x32_bf16 v[44:59], v[92:95], v[4:11], v3
    v_exp_f32 v14, v14
    v_exp_f32 v15, v15
    v_exp_f32 v16, v16
    v_exp_f32 v17, v17
    v_exp_f32 v18, v18
    v_exp_f32 v19, v19
    v_exp_f32 v20, v20
    v_exp_f32 v21, v21
    v_smfmac_f32_32x32x32_bf16 v[44:59], v[96:99], v[12:19], v3
    v_exp_f32 v22, v22
    v_exp_f32 v23, v23
    v_exp_f32 v24, v24
    s_waitcnt lgkmcnt(0)
    v_mfma_f32_32x32x16_bf16 v[4:19], v[76:79], v[36:39], 0
    v_exp_f32 v25, v25
    v_exp_f32 v26, v26
    v_exp_f32 v27, v27
    v_exp_f32 v28, v28
    v_exp_f32 v29, v29
    v_smfmac_f32_32x32x32_bf16 v[60:75], v[92:95], v[20:27], v3
    v_exp_f32 v30, v30
    v_exp_f32 v31, v31
    v_exp_f32 v32, v32
    v_exp_f32 v33, v33
    v_exp_f32 v34, v34
    v_exp_f32 v35, v35
    s_waitcnt vmcnt(0)
    v_cmp_ne_u32 vcc, s49, v103
    s_mov_b32 s50, 0
    s_cbranch_vccnz L_f2_spin
L_f2_ok:
    buffer_load_dwordx4 v[112:115], v232, s[8:11], s76 offen offset:0 sc1
    buffer_load_dwordx4 v[116:119], v232, s[8:11], s76 offen offset:16 sc1
    buffer_load_dwordx4 v[104:107], v2, s[8:11], s77 offen sc1
    buffer_load_dwordx2 v[108:109], v233, s[8:11], s78 offen sc1
    v_exp_f32 v4, v4
    v_exp_f32 v5, v5
    v_smfmac_f32_32x32x32_bf16 v[60:75], v[96:99], v[28:35], v3
    s_mov_b64 exec, s[56:57]
    ds_read_b128 v[92:95], v227 offset:35840
    ds_read_b128 v[96:99], v227 offset:36352
    s_mov_b64 exec, -1
    v_exp_f32 v6, v6
    v_exp_f32 v7, v7
    v_exp_f32 v8, v8
    v_mfma_f32_32x32x16_bf16 v[20:35], v[76:79], v[40:43], 0
    ds_read_b128 v[76:79], v226 offset:49152
    v_exp_f32 v9, v9
    v_exp_f32 v10, v10
    v_exp_f32 v11, v11
    v_exp_f32 v12, v12
    v_exp_f32 v13, v13
    v_smfmac_f32_32x32x32_bf16 v[44:59], v[84:87], v[4:11], v3
    v_exp_f32 v14, v14
    v_exp_f32 v15, v15
    v_exp_f32 v16, v16
    v_exp_f32 v17, v17
    v_exp_f32 v18, v18
    v_exp_f32 v19, v19
    buffer_load_dwordx4 v[120:123], v232, s[8:11], s76 offen offset:1088 sc1
    buffer_load_dwordx4 v[124:127], v232, s[8:11], s76 offen offset:1104 sc1
    v_exp_f32 v20, v20
    v_exp_f32 v21, v21
    v_smfmac_f32_32x32x32_bf16 v[44:59], v[88:91], v[12:19], v3
    v_exp_f32 v22, v22
    v_exp_f32 v23, v23
    v_exp_f32 v24, v24
    s_waitcnt lgkmcnt(0)
    v_mfma_f32_32x32x16_bf16 v[4:19], v[80:83], v[36:39], 0
    v_exp_f32 v25, v25
    v_exp_f32 v26, v26
    v_exp_f32 v27, v27
    v_exp_f32 v28, v28
    v_exp_f32 v29, v29
    v_smfmac_f32_32x32x32_bf16 v[60:75], v[84:87], v[20:27], v3
    v_exp_f32 v30, v30
    v_exp_f32 v31, v31
    v_exp_f32 v32, v32
    v_exp_f32 v33, v33
    v_exp_f32 v34, v34
    v_exp_f32 v35, v35
    buffer_load_dwordx4 v[128:131], v232, s[8:11], s76 offen offset:2176 sc1
    buffer_load_dwordx4 v[132:135], v232, s[8:11], s76 offen offset:2192 sc1
    v_exp_f32 v4, v4
    v_exp_f32 v5, v5
    v_smfmac_f32_32x32x32_bf16 v[60:75], v[88:91], v[28:35], v3
    s_mov_b64 exec, s[56:57]
    ds_read_b128 v[84:87], v227 offset:49152
    ds_read_b128 v[88:91], v227 offset:49664
    s_mov_b64 exec, -1
    v_exp_f32 v6, v6
    v_exp_f32 v7, v7
    v_exp_f32 v8, v8
    v_mfma_f32_32x32x16_bf16 v[20:35], v[80:83], v[40:43], 0
    ds_read_b128 v[80:83], v226 offset:50176
    v_exp_f32 v9, v9
    v_exp_f32 v10, v10
    v_exp_f32 v11, v11
    v_exp_f32 v12, v12
    v_exp_f32 v13, v13
    v_smfmac_f32_32x32x32_bf16 v[44:59], v[92:95], v[4:11], v3
    v_exp_f32 v14, v14
    v_exp_f32 v15, v15
    v_exp_f32 v16, v16
    v_exp_f32 v17, v17
    v_exp_f32 v18, v18
    v_exp_f32 v19, v19
    buffer_load_dwordx4 v[136:139], v232, s[8:11], s76 offen offset:3264 sc1
    buffer_load_dwordx4 v[140:143], v232, s[8:11], s76 offen offset:3280 sc1
    v_exp_f32 v20, v20
    v_exp_f32 v21, v21
    v_smfmac_f32_32x32x32_bf16 v[44:59], v[96:99], v[12:19], v3
    v_exp_f32 v22, v22
    v_exp_f32 v23, v23
    v_exp_f32 v24, v24
    s_waitcnt lgkmcnt(0)
    v_mfma_f32_32x32x16_bf16 v[4:19], v[76:79], v[36:39], 0
    v_exp_f32 v25, v25
    v_exp_f32 v26, v26
    v_exp_f32 v27, v27
    v_exp_f32 v28, v28
    v_exp_f32 v29, v29
    v_smfmac_f32_32x32x32_bf16 v[60:75], v[92:95], v[20:27], v3
    v_exp_f32 v30, v30
    v_exp_f32 v31, v31
    v_exp_f32 v32, v32
    v_exp_f32 v33, v33
    v_exp_f32 v34, v34
    v_exp_f32 v35, v35
    v_exp_f32 v4, v4
    v_exp_f32 v5, v5
    v_smfmac_f32_32x32x32_bf16 v[60:75], v[96:99], v[28:35], v3
    s_mov_b64 exec, s[56:57]
    ds_read_b128 v[92:95], v227 offset:50176
    ds_read_b128 v[96:99], v227 offset:50688
    s_mov_b64 exec, -1
    v_exp_f32 v6, v6
    v_exp_f32 v7, v7
    v_exp_f32 v8, v8
    v_mfma_f32_32x32x16_bf16 v[20:35], v[76:79], v[40:43], 0
    ds_read_b128 v[76:79], v226 offset:51200
    v_exp_f32 v9, v9
    v_exp_f32 v10, v10
    v_exp_f32 v11, v11
    v_exp_f32 v12, v12
    v_exp_f32 v13, v13
    v_smfmac_f32_32x32x32_bf16 v[44:59], v[84:87], v[4:11], v3
    v_exp_f32 v14, v14
    v_exp_f32 v15, v15
    v_exp_f32 v16, v16
    v_exp_f32 v17, v17
    v_exp_f32 v18, v18
    v_exp_f32 v19, v19
    v_exp_f32 v20, v20
    v_exp_f32 v21, v21
    v_smfmac_f32_32x32x32_bf16 v[44:59], v[88:91], v[12:19], v3
    v_exp_f32 v22, v22
    v_exp_f32 v23, v23
    v_exp_f32 v24, v24
    s_waitcnt lgkmcnt(0)
    v_mfma_f32_32x32x16_bf16 v[4:19], v[80:83], v[36:39], 0
    v_exp_f32 v25, v25
    v_exp_f32 v26, v26
    v_exp_f32 v27, v27
    v_exp_f32 v28, v28
    v_exp_f32 v29, v29
    v_smfmac_f32_32x32x32_bf16 v[60:75], v[84:87], v[20:27], v3
    v_exp_f32 v30, v30
    v_exp_f32 v31, v31
    v_exp_f32 v32, v32
    v_exp_f32 v33, v33
    v_exp_f32 v34, v34
    v_exp_f32 v35, v35
    v_exp_f32 v4, v4
    v_exp_f32 v5, v5
    v_smfmac_f32_32x32x32_bf16 v[60:75], v[88:91], v[28:35], v3
    s_mov_b64 exec, s[56:57]
    ds_read_b128 v[84:87], v227 offset:51200
    ds_read_b128 v[88:91], v227 offset:51712
    s_mov_b64 exec, -1
    v_exp_f32 v6, v6
    v_exp_f32 v7, v7
    v_exp_f32 v8, v8
    v_mfma_f32_32x32x16_bf16 v[20:35], v[80:83], v[40:43], 0
    ds_read_b128 v[80:83], v226 offset:52224
    v_exp_f32 v9, v9
    v_exp_f32 v10, v10
    v_exp_f32 v11, v11
    v_exp_f32 v12, v12
    v_exp_f32 v13, v13
    v_smfmac_f32_32x32x32_bf16 v[44:59], v[92:95], v[4:11], v3
    v_exp_f32 v14, v14
    v_exp_f32 v15, v15
    v_exp_f32 v16, v16
    v_exp_f32 v17, v17
    v_exp_f32 v18, v18
    v_exp_f32 v19, v19
    s_waitcnt vmcnt(0)
    v_pk_add_f32 v[112:113], v[112:113], v[120:121]
    v_pk_add_f32 v[114:115], v[114:115], v[122:123]
    v_pk_add_f32 v[116:117], v[116:117], v[124:125]
    v_pk_add_f32 v[118:119], v[118:119], v[126:127]
    v_pk_add_f32 v[128:129], v[128:129], v[136:137]
    v_pk_add_f32 v[130:131], v[130:131], v[138:139]
    v_pk_add_f32 v[132:133], v[132:133], v[140:141]
    v_pk_add_f32 v[134:135], v[134:135], v[142:143]
    v_pk_add_f32 v[112:113], v[112:113], v[128:129]
    v_pk_add_f32 v[114:115], v[114:115], v[130:131]
    v_pk_add_f32 v[116:117], v[116:117], v[132:133]
    v_pk_add_f32 v[118:119], v[118:119], v[134:135]
    v_cvt_pk_bf16_f32 v112, v112, v113
    v_cvt_pk_bf16_f32 v113, v114, v115
    v_cvt_pk_bf16_f32 v114, v116, v117
    v_cvt_pk_bf16_f32 v115, v118, v119
    ds_write_b128 v234, v[112:115]
    v_exp_f32 v20, v20
    v_exp_f32 v21, v21
    v_smfmac_f32_32x32x32_bf16 v[44:59], v[96:99], v[12:19], v3
    v_exp_f32 v22, v22
    v_exp_f32 v23, v23
    v_exp_f32 v24, v24
    s_waitcnt lgkmcnt(0)
    v_mfma_f32_32x32x16_bf16 v[4:19], v[76:79], v[36:39], 0
    v_exp_f32 v25, v25
    v_exp_f32 v26, v26
    v_exp_f32 v27, v27
    v_exp_f32 v28, v28
    v_exp_f32 v29, v29
    v_smfmac_f32_32x32x32_bf16 v[60:75], v[92:95], v[20:27], v3
    v_exp_f32 v30, v30
    v_exp_f32 v31, v31
    v_exp_f32 v32, v32
    v_exp_f32 v33, v33
    v_exp_f32 v34, v34
    v_exp_f32 v35, v35
    s_waitcnt lgkmcnt(0)
    s_barrier
    v_add_u32 v226, 0x10000, v226
    ds_read_b128 v[144:147], v235 offset:0
    ds_read_b128 v[148:151], v235 offset:2048
    ds_read_b128 v[152:155], v235 offset:4096
    ds_read_b128 v[156:159], v235 offset:6144
    ds_read_b128 v[160:163], v235 offset:8192
    ds_read_b128 v[164:167], v235 offset:10240
    ds_read_b128 v[168:171], v235 offset:12288
    ds_read_b128 v[172:175], v235 offset:14336
    v_exp_f32 v4, v4
    v_exp_f32 v5, v5
    v_smfmac_f32_32x32x32_bf16 v[60:75], v[96:99], v[28:35], v3
    s_mov_b64 exec, s[56:57]
    ds_read_b128 v[92:95], v227 offset:52224
    ds_read_b128 v[96:99], v227 offset:52736
    s_mov_b64 exec, -1
    v_exp_f32 v6, v6
    v_exp_f32 v7, v7
    v_exp_f32 v8, v8
    v_mfma_f32_32x32x16_bf16 v[20:35], v[76:79], v[40:43], 0
    ds_read_b128 v[76:79], v226 offset:0
    v_exp_f32 v9, v9
    v_exp_f32 v10, v10
    v_exp_f32 v11, v11
    v_exp_f32 v12, v12
    v_exp_f32 v13, v13
    v_smfmac_f32_32x32x32_bf16 v[44:59], v[84:87], v[4:11], v3
    v_exp_f32 v14, v14
    v_exp_f32 v15, v15
    v_exp_f32 v16, v16
    v_exp_f32 v17, v17
    v_exp_f32 v18, v18
    v_exp_f32 v19, v19
    v_exp_f32 v20, v20
    v_exp_f32 v21, v21
    v_smfmac_f32_32x32x32_bf16 v[44:59], v[88:91], v[12:19], v3
    v_exp_f32 v22, v22
    v_exp_f32 v23, v23
    v_exp_f32 v24, v24
    s_waitcnt lgkmcnt(0)
    v_mfma_f32_32x32x16_bf16 v[4:19], v[80:83], v[36:39], 0
    v_exp_f32 v25, v25
    v_exp_f32 v26, v26
    v_exp_f32 v27, v27
    v_exp_f32 v28, v28
    v_exp_f32 v29, v29
    v_smfmac_f32_32x32x32_bf16 v[60:75], v[84:87], v[20:27], v3
    v_exp_f32 v30, v30
    v_exp_f32 v31, v31
    v_exp_f32 v32, v32
    v_exp_f32 v33, v33
    v_exp_f32 v34, v34
    v_exp_f32 v35, v35
    v_add_u32 v227, 0x10000, v227
    v_exp_f32 v4, v4
    v_exp_f32 v5, v5
    v_smfmac_f32_32x32x32_bf16 v[60:75], v[88:91], v[28:35], v3
    s_mov_b64 exec, s[56:57]
    ds_read_b128 v[84:87], v227 offset:0
    ds_read_b128 v[88:91], v227 offset:512
    s_mov_b64 exec, -1
    v_exp_f32 v6, v6
    v_exp_f32 v7, v7
    v_exp_f32 v8, v8
    v_mfma_f32_32x32x16_bf16 v[20:35], v[80:83], v[40:43], 0
    ds_read_b128 v[80:83], v226 offset:1024
    v_exp_f32 v9, v9
    v_exp_f32 v10, v10
    v_exp_f32 v11, v11
    v_exp_f32 v12, v12
    v_exp_f32 v13, v13
    v_smfmac_f32_32x32x32_bf16 v[44:59], v[92:95], v[4:11], v3
    v_exp_f32 v14, v14
    v_exp_f32 v15, v15
    v_exp_f32 v16, v16
    v_mfma_f32_32x32x16_bf16 v[112:127], v[144:147], v[104:107], 0
    v_exp_f32 v17, v17
    v_exp_f32 v18, v18
    v_exp_f32 v19, v19
    v_exp_f32 v20, v20
    v_exp_f32 v21, v21
    v_smfmac_f32_32x32x32_bf16 v[44:59], v[96:99], v[12:19], v3
    v_exp_f32 v22, v22
    v_exp_f32 v23, v23
    v_exp_f32 v24, v24
    s_waitcnt lgkmcnt(0)
    v_mfma_f32_32x32x16_bf16 v[4:19], v[76:79], v[36:39], 0
    v_exp_f32 v25, v25
    v_exp_f32 v26, v26
    v_exp_f32 v27, v27
    v_exp_f32 v28, v28
    v_exp_f32 v29, v29
    v_smfmac_f32_32x32x32_bf16 v[60:75], v[92:95], v[20:27], v3
    v_exp_f32 v30, v30
    v_exp_f32 v31, v31
    v_exp_f32 v32, v32
    v_mfma_f32_32x32x16_bf16 v[112:127], v[148:151], v[104:107], v[112:127]
    v_exp_f32 v33, v33
    v_exp_f32 v34, v34
    v_exp_f32 v35, v35
    v_exp_f32 v4, v4
    v_exp_f32 v5, v5
    v_smfmac_f32_32x32x32_bf16 v[60:75], v[96:99], v[28:35], v3
    s_mov_b64 exec, s[56:57]
    ds_read_b128 v[92:95], v227 offset:1024
    ds_read_b128 v[96:99], v227 offset:1536
    s_mov_b64 exec, -1
    v_exp_f32 v6, v6
    v_exp_f32 v7, v7
    v_exp_f32 v8, v8
    v_mfma_f32_32x32x16_bf16 v[20:35], v[76:79], v[40:43], 0
    ds_read_b128 v[76:79], v226 offset:2048
    v_exp_f32 v9, v9
    v_exp_f32 v10, v10
    v_exp_f32 v11, v11
    v_exp_f32 v12, v12
    v_exp_f32 v13, v13
    v_smfmac_f32_32x32x32_bf16 v[44:59], v[84:87], v[4:11], v3
    v_exp_f32 v14, v14
    v_exp_f32 v15, v15
    v_exp_f32 v16, v16
    v_mfma_f32_32x32x16_bf16 v[112:127], v[152:155], v[104:107], v[112:127]
    v_exp_f32 v17, v17
    v_exp_f32 v18, v18
    v_exp_f32 v19, v19
    v_exp_f32 v20, v20
    v_exp_f32 v21, v21
    v_smfmac_f32_32x32x32_bf16 v[44:59], v[88:91], v[12:19], v3
    v_exp_f32 v22, v22
    v_exp_f32 v23, v23
    v_exp_f32 v24, v24
    s_waitcnt lgkmcnt(0)
    v_mfma_f32_32x32x16_bf16 v[4:19], v[80:83], v[36:39], 0
    v_exp_f32 v25, v25
    v_exp_f32 v26, v26
    v_exp_f32 v27, v27
    v_exp_f32 v28, v28
    v_exp_f32 v29, v29
    v_smfmac_f32_32x32x32_bf16 v[60:75], v[84:87], v[20:27], v3
    v_exp_f32 v30, v30
    v_exp_f32 v31, v31
    v_exp_f32 v32, v32
    v_mfma_f32_32x32x16_bf16 v[112:127], v[156:159], v[104:107], v[112:127]
    v_exp_f32 v33, v33
    v_exp_f32 v34, v34
    v_exp_f32 v35, v35
    v_exp_f32 v4, v4
    v_exp_f32 v5, v5
    v_smfmac_f32_32x32x32_bf16 v[60:75], v[88:91], v[28:35], v3
    s_mov_b64 exec, s[56:57]
    ds_read_b128 v[84:87], v227 offset:2048
    ds_read_b128 v[88:91], v227 offset:2560
    s_mov_b64 exec, -1
    v_exp_f32 v6, v6
    v_exp_f32 v7, v7
    v_exp_f32 v8, v8
    v_mfma_f32_32x32x16_bf16 v[20:35], v[80:83], v[40:43], 0
    ds_read_b128 v[80:83], v226 offset:3072
    v_exp_f32 v9, v9
    v_exp_f32 v10, v10
    v_exp_f32 v11, v11
    v_exp_f32 v12, v12
    v_exp_f32 v13, v13
    v_smfmac_f32_32x32x32_bf16 v[44:59], v[92:95], v[4:11], v3
    v_exp_f32 v14, v14
    v_exp_f32 v15, v15
    v_exp_f32 v16, v16
    v_mfma_f32_32x32x16_bf16 v[112:127], v[160:163], v[104:107], v[112:127]
    v_exp_f32 v17, v17
    v_exp_f32 v18, v18
    v_exp_f32 v19, v19
    v_exp_f32 v20, v20
    v_exp_f32 v21, v21
    v_smfmac_f32_32x32x32_bf16 v[44:59], v[96:99], v[12:19], v3
    v_exp_f32 v22, v22
    v_exp_f32 v23, v23
    v_exp_f32 v24, v24
    s_waitcnt lgkmcnt(0)
    v_mfma_f32_32x32x16_bf16 v[4:19], v[76:79], v[36:39], 0
    v_exp_f32 v25, v25
    v_exp_f32 v26, v26
    v_exp_f32 v27, v27
    v_exp_f32 v28, v28
    v_exp_f32 v29, v29
    v_smfmac_f32_32x32x32_bf16 v[60:75], v[92:95], v[20:27], v3
    v_exp_f32 v30, v30
    v_exp_f32 v31, v31
    v_exp_f32 v32, v32
    v_mfma_f32_32x32x16_bf16 v[112:127], v[164:167], v[104:107], v[112:127]
    v_exp_f32 v33, v33
    v_exp_f32 v34, v34
    v_exp_f32 v35, v35
    v_exp_f32 v4, v4
    v_exp_f32 v5, v5
    v_smfmac_f32_32x32x32_bf16 v[60:75], v[96:99], v[28:35], v3
    s_mov_b64 exec, s[56:57]
    ds_read_b128 v[92:95], v227 offset:3072
    ds_read_b128 v[96:99], v227 offset:3584
    s_mov_b64 exec, -1
    v_exp_f32 v6, v6
    v_exp_f32 v7, v7
    v_exp_f32 v8, v8
    v_mfma_f32_32x32x16_bf16 v[20:35], v[76:79], v[40:43], 0
    ds_read_b128 v[76:79], v226 offset:16384
    v_exp_f32 v9, v9
    v_exp_f32 v10, v10
    v_exp_f32 v11, v11
    v_exp_f32 v12, v12
    v_exp_f32 v13, v13
    v_smfmac_f32_32x32x32_bf16 v[44:59], v[84:87], v[4:11], v3
    v_exp_f32 v14, v14
    v_exp_f32 v15, v15
    v_exp_f32 v16, v16
    v_mfma_f32_32x32x16_bf16 v[112:127], v[168:171], v[104:107], v[112:127]
    v_exp_f32 v17, v17
    v_exp_f32 v18, v18
    v_exp_f32 v19, v19
    v_exp_f32 v20, v20
    v_exp_f32 v21, v21
    v_smfmac_f32_32x32x32_bf16 v[44:59], v[88:91], v[12:19], v3
    v_exp_f32 v22, v22
    v_exp_f32 v23, v23
    v_exp_f32 v24, v24
    s_waitcnt lgkmcnt(0)
    v_mfma_f32_32x32x16_bf16 v[4:19], v[80:83], v[36:39], 0
    v_exp_f32 v25, v25
    v_exp_f32 v26, v26
    v_exp_f32 v27, v27
    v_exp_f32 v28, v28
    v_exp_f32 v29, v29
    v_smfmac_f32_32x32x32_bf16 v[60:75], v[84:87], v[20:27], v3
    v_exp_f32 v30, v30
    v_exp_f32 v31, v31
    v_exp_f32 v32, v32
    v_mfma_f32_32x32x16_bf16 v[112:127], v[172:175], v[104:107], v[112:127]
    v_exp_f32 v33, v33
    v_exp_f32 v34, v34
    v_exp_f32 v35, v35
    v_exp_f32 v4, v4
    v_exp_f32 v5, v5
    v_smfmac_f32_32x32x32_bf16 v[60:75], v[88:91], v[28:35], v3
    s_mov_b64 exec, s[56:57]
    ds_read_b128 v[84:87], v227 offset:16384
    ds_read_b128 v[88:91], v227 offset:16896
    s_mov_b64 exec, -1
    v_exp_f32 v6, v6
    v_exp_f32 v7, v7
    v_exp_f32 v8, v8
    v_mfma_f32_32x32x16_bf16 v[20:35], v[80:83], v[40:43], 0
    ds_read_b128 v[80:83], v226 offset:17408
    v_exp_f32 v9, v9
    v_exp_f32 v10, v10
    v_exp_f32 v11, v11
    v_exp_f32 v12, v12
    v_exp_f32 v13, v13
    v_smfmac_f32_32x32x32_bf16 v[44:59], v[92:95], v[4:11], v3
    v_exp_f32 v14, v14
    v_exp_f32 v15, v15
    v_exp_f32 v16, v16
    v_exp_f32 v17, v17
    v_exp_f32 v18, v18
    v_exp_f32 v19, v19
    v_add_f32 v110, s54, v120
    v_rcp_f32 v110, v110
    s_nop 0
    v_mul_f32 v110, v110, v109
    v_pk_mul_f32 v[112:113], v[112:113], v[110:111] op_sel_hi:[1,0]
    v_pk_mul_f32 v[114:115], v[114:115], v[110:111] op_sel_hi:[1,0]
    v_pk_mul_f32 v[116:117], v[116:117], v[110:111] op_sel_hi:[1,0]
    v_pk_mul_f32 v[118:119], v[118:119], v[110:111] op_sel_hi:[1,0]
    v_cvt_pk_bf16_f32 v112, v112, v113
    v_cvt_pk_bf16_f32 v113, v114, v115
    v_cvt_pk_bf16_f32 v114, v116, v117
    v_cvt_pk_bf16_f32 v115, v118, v119
    buffer_store_dwordx4 v[112:115], v2, s[8:11], s79 offen sc1
    v_exp_f32 v20, v20
    v_exp_f32 v21, v21
    v_smfmac_f32_32x32x32_bf16 v[44:59], v[96:99], v[12:19], v3
    v_exp_f32 v22, v22
    v_exp_f32 v23, v23
    v_exp_f32 v24, v24
    s_waitcnt lgkmcnt(0)
    v_mfma_f32_32x32x16_bf16 v[4:19], v[76:79], v[36:39], 0
    v_exp_f32 v25, v25
    v_exp_f32 v26, v26
    v_exp_f32 v27, v27
    v_exp_f32 v28, v28
    v_exp_f32 v29, v29
    v_smfmac_f32_32x32x32_bf16 v[60:75], v[92:95], v[20:27], v3
    v_exp_f32 v30, v30
    v_exp_f32 v31, v31
    v_exp_f32 v32, v32
    v_exp_f32 v33, v33
    v_exp_f32 v34, v34
    v_exp_f32 v35, v35
    s_mov_b64 exec, 0xffff
    buffer_load_dword v111, v253, s[32:35], s82 offen
    buffer_load_dword v111, v253, s[28:31], s82 offen
    s_mov_b64 exec, -1
    v_exp_f32 v4, v4
    v_exp_f32 v5, v5
    v_smfmac_f32_32x32x32_bf16 v[60:75], v[96:99], v[28:35], v3
    s_mov_b64 exec, s[56:57]
    ds_read_b128 v[92:95], v227 offset:17408
    ds_read_b128 v[96:99], v227 offset:17920
    s_mov_b64 exec, -1
    v_exp_f32 v6, v6
    v_exp_f32 v7, v7
    v_exp_f32 v8, v8
    v_mfma_f32_32x32x16_bf16 v[20:35], v[76:79], v[40:43], 0
    ds_read_b128 v[76:79], v226 offset:18432
    v_exp_f32 v9, v9
    v_exp_f32 v10, v10
    v_exp_f32 v11, v11
    v_exp_f32 v12, v12
    v_exp_f32 v13, v13
    v_smfmac_f32_32x32x32_bf16 v[44:59], v[84:87], v[4:11], v3
    v_exp_f32 v14, v14
    v_exp_f32 v15, v15
    v_exp_f32 v16, v16
    v_exp_f32 v17, v17
    v_exp_f32 v18, v18
    v_exp_f32 v19, v19
    v_exp_f32 v20, v20
    v_exp_f32 v21, v21
    v_smfmac_f32_32x32x32_bf16 v[44:59], v[88:91], v[12:19], v3
    v_exp_f32 v22, v22
    v_exp_f32 v23, v23
    v_exp_f32 v24, v24
    s_waitcnt lgkmcnt(0)
    v_mfma_f32_32x32x16_bf16 v[4:19], v[80:83], v[36:39], 0
    v_exp_f32 v25, v25
    v_exp_f32 v26, v26
    v_exp_f32 v27, v27
    v_exp_f32 v28, v28
    v_exp_f32 v29, v29
    v_smfmac_f32_32x32x32_bf16 v[60:75], v[84:87], v[20:27], v3
    v_exp_f32 v30, v30
    v_exp_f32 v31, v31
    v_exp_f32 v32, v32
    v_exp_f32 v33, v33
    v_exp_f32 v34, v34
    v_exp_f32 v35, v35
    v_exp_f32 v4, v4
    v_exp_f32 v5, v5
    v_smfmac_f32_32x32x32_bf16 v[60:75], v[88:91], v[28:35], v3
    s_mov_b64 exec, s[56:57]
    ds_read_b128 v[84:87], v227 offset:18432
    ds_read_b128 v[88:91], v227 offset:18944
    s_mov_b64 exec, -1
    v_exp_f32 v6, v6
    v_exp_f32 v7, v7
    v_exp_f32 v8, v8
    v_mfma_f32_32x32x16_bf16 v[20:35], v[80:83], v[40:43], 0
    ds_read_b128 v[80:83], v226 offset:19456
    v_exp_f32 v9, v9
    v_exp_f32 v10, v10
    v_exp_f32 v11, v11
    v_exp_f32 v12, v12
    v_exp_f32 v13, v13
    v_smfmac_f32_32x32x32_bf16 v[44:59], v[92:95], v[4:11], v3
    v_exp_f32 v14, v14
    v_exp_f32 v15, v15
    v_exp_f32 v16, v16
    v_exp_f32 v17, v17
    v_exp_f32 v18, v18
    v_exp_f32 v19, v19
    v_exp_f32 v20, v20
    v_exp_f32 v21, v21
    v_smfmac_f32_32x32x32_bf16 v[44:59], v[96:99], v[12:19], v3
    v_exp_f32 v22, v22
    v_exp_f32 v23, v23
    v_exp_f32 v24, v24
    s_waitcnt lgkmcnt(0)
    v_mfma_f32_32x32x16_bf16 v[4:19], v[76:79], v[36:39], 0
    v_exp_f32 v25, v25
    v_exp_f32 v26, v26
    v_exp_f32 v27, v27
    v_exp_f32 v28, v28
    v_exp_f32 v29, v29
    v_smfmac_f32_32x32x32_bf16 v[60:75], v[92:95], v[20:27], v3
    v_exp_f32 v30, v30
    v_exp_f32 v31, v31
    v_exp_f32 v32, v32
    v_exp_f32 v33, v33
    v_exp_f32 v34, v34
    v_exp_f32 v35, v35
    v_exp_f32 v4, v4
    v_exp_f32 v5, v5
    v_smfmac_f32_32x32x32_bf16 v[60:75], v[96:99], v[28:35], v3
    s_mov_b64 exec, s[56:57]
    ds_read_b128 v[92:95], v227 offset:19456
    ds_read_b128 v[96:99], v227 offset:19968
    s_mov_b64 exec, -1
    v_exp_f32 v6, v6
    v_exp_f32 v7, v7
    v_exp_f32 v8, v8
    v_mfma_f32_32x32x16_bf16 v[20:35], v[76:79], v[40:43], 0
    ds_read_b128 v[76:79], v226 offset:32768
    v_exp_f32 v9, v9
    v_exp_f32 v10, v10
    v_exp_f32 v11, v11
    v_exp_f32 v12, v12
    v_exp_f32 v13, v13
    v_smfmac_f32_32x32x32_bf16 v[44:59], v[84:87], v[4:11], v3
    v_exp_f32 v14, v14
    v_exp_f32 v15, v15
    v_exp_f32 v16, v16
    v_exp_f32 v17, v17
    v_exp_f32 v18, v18
    v_exp_f32 v19, v19
    s_waitcnt vmcnt(0)
    s_mov_b64 exec, 1
    buffer_store_dword v251, v252, s[8:11], s81 offen sc1
    s_mov_b64 exec, -1
    v_exp_f32 v20, v20
    v_exp_f32 v21, v21
    v_smfmac_f32_32x32x32_bf16 v[44:59], v[88:91], v[12:19], v3
    v_exp_f32 v22, v22
    v_exp_f32 v23, v23
    v_exp_f32 v24, v24
    s_waitcnt lgkmcnt(0)
    v_mfma_f32_32x32x16_bf16 v[4:19], v[80:83], v[36:39], 0
    v_exp_f32 v25, v25
    v_exp_f32 v26, v26
    v_exp_f32 v27, v27
    v_exp_f32 v28, v28
    v_exp_f32 v29, v29
    v_smfmac_f32_32x32x32_bf16 v[60:75], v[84:87], v[20:27], v3
    v_exp_f32 v30, v30
    v_exp_f32 v31, v31
    v_exp_f32 v32, v32
    v_exp_f32 v33, v33
    v_exp_f32 v34, v34
    v_exp_f32 v35, v35
    v_exp_f32 v4, v4
    v_exp_f32 v5, v5
    v_smfmac_f32_32x32x32_bf16 v[60:75], v[88:91], v[28:35], v3
    s_mov_b64 exec, s[56:57]
    ds_read_b128 v[84:87], v227 offset:32768
    ds_read_b128 v[88:91], v227 offset:33280
    s_mov_b64 exec, -1
    v_exp_f32 v6, v6
    v_exp_f32 v7, v7
    v_exp_f32 v8, v8
    v_mfma_f32_32x32x16_bf16 v[20:35], v[80:83], v[40:43], 0
    ds_read_b128 v[80:83], v226 offset:33792
    v_exp_f32 v9, v9
    v_exp_f32 v10, v10
    v_exp_f32 v11, v11
    v_exp_f32 v12, v12
    v_exp_f32 v13, v13
    v_smfmac_f32_32x32x32_bf16 v[44:59], v[92:95], v[4:11], v3
    v_exp_f32 v14, v14
    v_exp_f32 v15, v15
    v_exp_f32 v16, v16
    v_exp_f32 v17, v17
    v_exp_f32 v18, v18
    v_exp_f32 v19, v19
    v_exp_f32 v20, v20
    v_exp_f32 v21, v21
    v_smfmac_f32_32x32x32_bf16 v[44:59], v[96:99], v[12:19], v3
    v_exp_f32 v22, v22
    v_exp_f32 v23, v23
    v_exp_f32 v24, v24
    s_waitcnt lgkmcnt(0)
    v_mfma_f32_32x32x16_bf16 v[4:19], v[76:79], v[36:39], 0
    v_exp_f32 v25, v25
    v_exp_f32 v26, v26
    v_exp_f32 v27, v27
    v_exp_f32 v28, v28
    v_exp_f32 v29, v29
    v_smfmac_f32_32x32x32_bf16 v[60:75], v[92:95], v[20:27], v3
    v_exp_f32 v30, v30
    v_exp_f32 v31, v31
    v_exp_f32 v32, v32
    v_exp_f32 v33, v33
    v_exp_f32 v34, v34
    v_exp_f32 v35, v35
    s_barrier
    s_add_u32 m0, s84, 0
    s_add_u32 s50, s83, 0
    buffer_load_dwordx4 v236, s[32:35], s50 offen lds
    s_add_u32 m0, s84, 8192
    s_add_u32 s50, s83, 65536
    buffer_load_dwordx4 v236, s[32:35], s50 offen lds
    v_exp_f32 v4, v4
    v_exp_f32 v5, v5
    v_smfmac_f32_32x32x32_bf16 v[60:75], v[96:99], v[28:35], v3
    s_mov_b64 exec, s[56:57]
    ds_read_b128 v[92:95], v227 offset:33792
    ds_read_b128 v[96:99], v227 offset:34304
    s_mov_b64 exec, -1
    v_exp_f32 v6, v6
    v_exp_f32 v7, v7
    v_exp_f32 v8, v8
    v_mfma_f32_32x32x16_bf16 v[20:35], v[76:79], v[40:43], 0
    ds_read_b128 v[76:79], v226 offset:34816
    v_exp_f32 v9, v9
    v_exp_f32 v10, v10
    v_exp_f32 v11, v11
    v_exp_f32 v12, v12
    v_exp_f32 v13, v13
    v_smfmac_f32_32x32x32_bf16 v[44:59], v[84:87], v[4:11], v3
    v_exp_f32 v14, v14
    v_exp_f32 v15, v15
    v_exp_f32 v16, v16
    v_exp_f32 v17, v17
    v_exp_f32 v18, v18
    v_exp_f32 v19, v19
    s_add_u32 m0, s84, 16384
    s_add_u32 s50, s83, 131072
    buffer_load_dwordx4 v236, s[32:35], s50 offen lds
    s_add_u32 m0, s84, 24576
    s_add_u32 s50, s83, 196608
    buffer_load_dwordx4 v236, s[32:35], s50 offen lds
    v_exp_f32 v20, v20
    v_exp_f32 v21, v21
    v_smfmac_f32_32x32x32_bf16 v[44:59], v[88:91], v[12:19], v3
    v_exp_f32 v22, v22
    v_exp_f32 v23, v23
    v_exp_f32 v24, v24
    s_waitcnt lgkmcnt(0)
    v_mfma_f32_32x32x16_bf16 v[4:19], v[80:83], v[36:39], 0
    v_exp_f32 v25, v25
    v_exp_f32 v26, v26
    v_exp_f32 v27, v27
    v_exp_f32 v28, v28
    v_exp_f32 v29, v29
    v_smfmac_f32_32x32x32_bf16 v[60:75], v[84:87], v[20:27], v3
    v_exp_f32 v30, v30
    v_exp_f32 v31, v31
    v_exp_f32 v32, v32
    v_exp_f32 v33, v33
    v_exp_f32 v34, v34
    v_exp_f32 v35, v35
    s_add_u32 m0, s84, 32768
    s_add_u32 s50, s83, 262144
    buffer_load_dwordx4 v236, s[32:35], s50 offen lds
    s_add_u32 m0, s84, 40960
    s_add_u32 s50, s83, 327680
    buffer_load_dwordx4 v236, s[32:35], s50 offen lds
    v_exp_f32 v4, v4
    v_exp_f32 v5, v5
    v_smfmac_f32_32x32x32_bf16 v[60:75], v[88:91], v[28:35], v3
    s_mov_b64 exec, s[56:57]
    ds_read_b128 v[84:87], v227 offset:34816
    ds_read_b128 v[88:91], v227 offset:35328
    s_mov_b64 exec, -1
    v_exp_f32 v6, v6
    v_exp_f32 v7, v7
    v_exp_f32 v8, v8
    v_mfma_f32_32x32x16_bf16 v[20:35], v[80:83], v[40:43], 0
    ds_read_b128 v[80:83], v226 offset:35840
    v_exp_f32 v9, v9
    v_exp_f32 v10, v10
    v_exp_f32 v11, v11
    v_exp_f32 v12, v12
    v_exp_f32 v13, v13
    v_smfmac_f32_32x32x32_bf16 v[44:59], v[92:95], v[4:11], v3
    v_exp_f32 v14, v14
    v_exp_f32 v15, v15
    v_exp_f32 v16, v16
    v_exp_f32 v17, v17
    v_exp_f32 v18, v18
    v_exp_f32 v19, v19
    s_add_u32 m0, s84, 49152
    s_add_u32 s50, s83, 393216
    buffer_load_dwordx4 v236, s[32:35], s50 offen lds
    s_add_u32 m0, s84, 57344
    s_add_u32 s50, s83, 458752
    buffer_load_dwordx4 v236, s[32:35], s50 offen lds
    v_exp_f32 v20, v20
    v_exp_f32 v21, v21
    v_smfmac_f32_32x32x32_bf16 v[44:59], v[96:99], v[12:19], v3
    v_exp_f32 v22, v22
    v_exp_f32 v23, v23
    v_exp_f32 v24, v24
    s_waitcnt lgkmcnt(0)
    v_mfma_f32_32x32x16_bf16 v[4:19], v[76:79], v[36:39], 0
    v_exp_f32 v25, v25
    v_exp_f32 v26, v26
    v_exp_f32 v27, v27
    v_exp_f32 v28, v28
    v_exp_f32 v29, v29
    v_smfmac_f32_32x32x32_bf16 v[60:75], v[92:95], v[20:27], v3
    v_exp_f32 v30, v30
    v_exp_f32 v31, v31
    v_exp_f32 v32, v32
    v_exp_f32 v33, v33
    v_exp_f32 v34, v34
    v_exp_f32 v35, v35
    s_add_u32 m0, s84, 65536
    s_add_u32 s50, s83, 0
    buffer_load_dwordx4 v236, s[28:31], s50 offen lds
    s_add_u32 m0, s84, 73728
    s_add_u32 s50, s83, 65536
    buffer_load_dwordx4 v236, s[28:31], s50 offen lds
    v_exp_f32 v4, v4
    v_exp_f32 v5, v5
    v_smfmac_f32_32x32x32_bf16 v[60:75], v[96:99], v[28:35], v3
    s_mov_b64 exec, s[56:57]
    ds_read_b128 v[92:95], v227 offset:35840
    ds_read_b128 v[96:99], v227 offset:36352
    s_mov_b64 exec, -1
    v_exp_f32 v6, v6
    v_exp_f32 v7, v7
    v_exp_f32 v8, v8
    v_mfma_f32_32x32x16_bf16 v[20:35], v[76:79], v[40:43], 0
    ds_read_b128 v[76:79], v226 offset:49152
    v_exp_f32 v9, v9
    v_exp_f32 v10, v10
    v_exp_f32 v11, v11
    v_exp_f32 v12, v12
    v_exp_f32 v13, v13
    v_smfmac_f32_32x32x32_bf16 v[44:59], v[84:87], v[4:11], v3
    v_exp_f32 v14, v14
    v_exp_f32 v15, v15
    v_exp_f32 v16, v16
    v_exp_f32 v17, v17
    v_exp_f32 v18, v18
    v_exp_f32 v19, v19
    s_add_u32 m0, s84, 81920
    s_add_u32 s50, s83, 131072
    buffer_load_dwordx4 v236, s[28:31], s50 offen lds
    s_add_u32 m0, s84, 90112
    s_add_u32 s50, s83, 196608
    buffer_load_dwordx4 v236, s[28:31], s50 offen lds
    v_exp_f32 v20, v20
    v_exp_f32 v21, v21
    v_smfmac_f32_32x32x32_bf16 v[44:59], v[88:91], v[12:19], v3
    v_exp_f32 v22, v22
    v_exp_f32 v23, v23
    v_exp_f32 v24, v24
    s_waitcnt lgkmcnt(0)
    v_mfma_f32_32x32x16_bf16 v[4:19], v[80:83], v[36:39], 0
    v_exp_f32 v25, v25
    v_exp_f32 v26, v26
    v_exp_f32 v27, v27
    v_exp_f32 v28, v28
    v_exp_f32 v29, v29
    v_smfmac_f32_32x32x32_bf16 v[60:75], v[84:87], v[20:27], v3
    v_exp_f32 v30, v30
    v_exp_f32 v31, v31
    v_exp_f32 v32, v32
    v_exp_f32 v33, v33
    v_exp_f32 v34, v34
    v_exp_f32 v35, v35
    v_exp_f32 v4, v4
    v_exp_f32 v5, v5
    v_smfmac_f32_32x32x32_bf16 v[60:75], v[88:91], v[28:35], v3
    s_mov_b64 exec, s[56:57]
    ds_read_b128 v[84:87], v227 offset:49152
    ds_read_b128 v[88:91], v227 offset:49664
    s_mov_b64 exec, -1
    v_exp_f32 v6, v6
    v_exp_f32 v7, v7
    v_exp_f32 v8, v8
    v_mfma_f32_32x32x16_bf16 v[20:35], v[80:83], v[40:43], 0
    ds_read_b128 v[80:83], v226 offset:50176
    v_exp_f32 v9, v9
    v_exp_f32 v10, v10
    v_exp_f32 v11, v11
    v_exp_f32 v12, v12
    v_exp_f32 v13, v13
    v_smfmac_f32_32x32x32_bf16 v[44:59], v[92:95], v[4:11], v3
    v_exp_f32 v14, v14
    v_exp_f32 v15, v15
    v_exp_f32 v16, v16
    v_exp_f32 v17, v17
    v_exp_f32 v18, v18
    v_exp_f32 v19, v19
    v_exp_f32 v20, v20
    v_exp_f32 v21, v21
    v_smfmac_f32_32x32x32_bf16 v[44:59], v[96:99], v[12:19], v3
    v_exp_f32 v22, v22
    v_exp_f32 v23, v23
    v_exp_f32 v24, v24
    s_waitcnt lgkmcnt(0)
    v_mfma_f32_32x32x16_bf16 v[4:19], v[76:79], v[36:39], 0
    v_exp_f32 v25, v25
    v_exp_f32 v26, v26
    v_exp_f32 v27, v27
    v_exp_f32 v28, v28
    v_exp_f32 v29, v29
    v_smfmac_f32_32x32x32_bf16 v[60:75], v[92:95], v[20:27], v3
    v_exp_f32 v30, v30
    v_exp_f32 v31, v31
    v_exp_f32 v32, v32
    v_exp_f32 v33, v33
    v_exp_f32 v34, v34
    v_exp_f32 v35, v35
    s_barrier
    s_add_u32 m0, s84, 98304
    s_add_u32 s50, s83, 262144
    buffer_load_dwordx4 v236, s[28:31], s50 offen lds
    s_add_u32 m0, s84, 106496
    s_add_u32 s50, s83, 327680
    buffer_load_dwordx4 v236, s[28:31], s50 offen lds
    v_exp_f32 v4, v4
    v_exp_f32 v5, v5
    v_smfmac_f32_32x32x32_bf16 v[60:75], v[96:99], v[28:35], v3
    s_mov_b64 exec, s[56:57]
    ds_read_b128 v[92:95], v227 offset:50176
    ds_read_b128 v[96:99], v227 offset:50688
    s_mov_b64 exec, -1
    v_exp_f32 v6, v6
    v_exp_f32 v7, v7
    v_exp_f32 v8, v8
    v_mfma_f32_32x32x16_bf16 v[20:35], v[76:79], v[40:43], 0
    ds_read_b128 v[76:79], v226 offset:51200
    v_exp_f32 v9, v9
    v_exp_f32 v10, v10
    v_exp_f32 v11, v11
    v_exp_f32 v12, v12
    v_exp_f32 v13, v13
    v_smfmac_f32_32x32x32_bf16 v[44:59], v[84:87], v[4:11], v3
    v_exp_f32 v14, v14
    v_exp_f32 v15, v15
    v_exp_f32 v16, v16
    v_exp_f32 v17, v17
    v_exp_f32 v18, v18
    v_exp_f32 v19, v19
    s_add_u32 m0, s84, 147456
    s_add_u32 s50, s83, 393216
    buffer_load_dwordx4 v236, s[28:31], s50 offen lds
    s_add_u32 m0, s84, 155648
    s_add_u32 s50, s83, 458752
    buffer_load_dwordx4 v236, s[28:31], s50 offen lds
    buffer_load_dword v103, v231, s[8:11], s85 offen sc1
    v_exp_f32 v20, v20
    v_exp_f32 v21, v21
    v_smfmac_f32_32x32x32_bf16 v[44:59], v[88:91], v[12:19], v3
    v_exp_f32 v22, v22
    v_exp_f32 v23, v23
    v_exp_f32 v24, v24
    s_waitcnt lgkmcnt(0)
    v_mfma_f32_32x32x16_bf16 v[4:19], v[80:83], v[36:39], 0
    v_exp_f32 v25, v25
    v_exp_f32 v26, v26
    v_exp_f32 v27, v27
    v_exp_f32 v28, v28
    v_exp_f32 v29, v29
    v_smfmac_f32_32x32x32_bf16 v[60:75], v[84:87], v[20:27], v3
    v_exp_f32 v30, v30
    v_exp_f32 v31, v31
    v_exp_f32 v32, v32
    v_exp_f32 v33, v33
    v_exp_f32 v34, v34
    v_exp_f32 v35, v35
    v_exp_f32 v4, v4
    v_exp_f32 v5, v5
    v_smfmac_f32_32x32x32_bf16 v[60:75], v[88:91], v[28:35], v3
    s_mov_b64 exec, s[56:57]
    ds_read_b128 v[84:87], v227 offset:51200
    ds_read_b128 v[88:91], v227 offset:51712
    s_mov_b64 exec, -1
    v_exp_f32 v6, v6
    v_exp_f32 v7, v7
    v_exp_f32 v8, v8
    v_mfma_f32_32x32x16_bf16 v[20:35], v[80:83], v[40:43], 0
    ds_read_b128 v[80:83], v226 offset:52224
    v_exp_f32 v9, v9
    v_exp_f32 v10, v10
    v_exp_f32 v11, v11
    v_exp_f32 v12, v12
    v_exp_f32 v13, v13
    v_smfmac_f32_32x32x32_bf16 v[44:59], v[92:95], v[4:11], v3
    v_exp_f32 v14, v14
    v_exp_f32 v15, v15
    v_exp_f32 v16, v16
    v_exp_f32 v17, v17
    v_exp_f32 v18, v18
    v_exp_f32 v19, v19
    s_waitcnt vmcnt(0)
    v_cmp_ne_u32 vcc, s49, v103
    s_mov_b32 s50, 0
    s_cbranch_vccnz L_f3_spin
L_f3_ok:
    buffer_load_dwordx4 v[144:147], v2, s[8:11], s86 offen offset:0 sc1
    buffer_load_dwordx4 v[148:151], v2, s[8:11], s86 offen offset:1024 sc1
    buffer_load_dwordx4 v[152:155], v2, s[8:11], s86 offen offset:2048 sc1
    buffer_load_dwordx4 v[156:159], v2, s[8:11], s86 offen offset:3072 sc1
    v_exp_f32 v20, v20
    v_exp_f32 v21, v21
    v_smfmac_f32_32x32x32_bf16 v[44:59], v[96:99], v[12:19], v3
    v_exp_f32 v22, v22
    v_exp_f32 v23, v23
    v_exp_f32 v24, v24
    s_waitcnt lgkmcnt(0)
    v_mfma_f32_32x32x16_bf16 v[4:19], v[76:79], v[36:39], 0
    v_exp_f32 v25, v25
    v_exp_f32 v26, v26
    v_exp_f32 v27, v27
    v_exp_f32 v28, v28
    v_exp_f32 v29, v29
    v_smfmac_f32_32x32x32_bf16 v[60:75], v[92:95], v[20:27], v3
    v_exp_f32 v30, v30
    v_exp_f32 v31, v31
    v_exp_f32 v32, v32
    v_exp_f32 v33, v33
    v_exp_f32 v34, v34
    v_exp_f32 v35, v35
    buffer_load_dwordx4 v[160:163], v2, s[8:11], s87 offen offset:0 sc1
    buffer_load_dwordx4 v[164:167], v2, s[8:11], s87 offen offset:1024 sc1
    buffer_load_dwordx4 v[168:171], v2, s[8:11], s87 offen offset:2048 sc1
    buffer_load_dwordx4 v[172:175], v2, s[8:11], s87 offen offset:3072 sc1
    v_exp_f32 v4, v4
    v_exp_f32 v5, v5
    v_smfmac_f32_32x32x32_bf16 v[60:75], v[96:99], v[28:35], v3
    s_mov_b64 exec, s[56:57]
    ds_read_b128 v[92:95], v227 offset:52224
    ds_read_b128 v[96:99], v227 offset:52736
    s_mov_b64 exec, -1
    v_exp_f32 v6, v6
    v_exp_f32 v7, v7
    v_exp_f32 v8, v8
    v_mfma_f32_32x32x16_bf16 v[20:35], v[76:79], v[40:43], 0
    v_exp_f32 v9, v9
    v_exp_f32 v10, v10
    v_exp_f32 v11, v11
    v_exp_f32 v12, v12
    v_exp_f32 v13, v13
    v_smfmac_f32_32x32x32_bf16 v[44:59], v[84:87], v[4:11], v3
    v_exp_f32 v14, v14
    v_exp_f32 v15, v15
    v_exp_f32 v16, v16
    v_exp_f32 v17, v17
    v_exp_f32 v18, v18
    v_exp_f32 v19, v19
    v_exp_f32 v20, v20
    v_exp_f32 v21, v21
    v_smfmac_f32_32x32x32_bf16 v[44:59], v[88:91], v[12:19], v3
    v_exp_f32 v22, v22
    v_exp_f32 v23, v23
    v_exp_f32 v24, v24
    s_waitcnt lgkmcnt(0)
    v_mfma_f32_32x32x16_bf16 v[4:19], v[80:83], v[36:39], 0
    v_exp_f32 v25, v25
    v_exp_f32 v26, v26
    v_exp_f32 v27, v27
    v_exp_f32 v28, v28
    v_exp_f32 v29, v29
    v_smfmac_f32_32x32x32_bf16 v[60:75], v[84:87], v[20:27], v3
    v_exp_f32 v30, v30
    v_exp_f32 v31, v31
    v_exp_f32 v32, v32
    v_exp_f32 v33, v33
    v_exp_f32 v34, v34
    v_exp_f32 v35, v35
    s_mov_b32 s4, 0x30800000
    s_mov_b32 s5, 0x5d800000
    s_movk_i32 s3, 0x207
    v_exp_f32 v4, v4
    v_exp_f32 v5, v5
    v_smfmac_f32_32x32x32_bf16 v[60:75], v[88:91], v[28:35], v3
    v_exp_f32 v6, v6
    v_exp_f32 v7, v7
    v_exp_f32 v8, v8
    v_mfma_f32_32x32x16_bf16 v[20:35], v[80:83], v[40:43], 0
    v_exp_f32 v9, v9
    v_exp_f32 v10, v10
    v_exp_f32 v11, v11
    v_exp_f32 v12, v12
    v_exp_f32 v13, v13
    v_smfmac_f32_32x32x32_bf16 v[44:59], v[92:95], v[4:11], v3
    v_exp_f32 v14, v14
    v_exp_f32 v15, v15
    v_exp_f32 v16, v16
    v_exp_f32 v17, v17
    v_exp_f32 v18, v18
    v_exp_f32 v19, v19
    v_exp_f32 v20, v20
    v_exp_f32 v21, v21
    v_smfmac_f32_32x32x32_bf16 v[44:59], v[96:99], v[12:19], v3
    v_exp_f32 v22, v22
    v_exp_f32 v23, v23
    v_exp_f32 v24, v24
    v_exp_f32 v25, v25
    v_exp_f32 v26, v26
    v_exp_f32 v27, v27
    v_exp_f32 v28, v28
    v_exp_f32 v29, v29
    v_smfmac_f32_32x32x32_bf16 v[60:75], v[92:95], v[20:27], v3
    v_exp_f32 v30, v30
    v_exp_f32 v31, v31
    v_exp_f32 v32, v32
    v_exp_f32 v33, v33
    v_exp_f32 v34, v34
L_tail:
    ds_write_b128 v234, v[44:47]
    ds_write_b128 v234, v[48:51] offset:1024
    ds_write_b32 v239, v52
    v_exp_f32 v35, v35
    s_nop 1
    v_smfmac_f32_32x32x32_bf16 v[60:75], v[96:99], v[28:35], v3
    s_setprio 0
    s_waitcnt vmcnt(0) lgkmcnt(0)
    s_barrier
    ds_read_b32 v120, v241
    ds_read_b128 v[112:115], v240
    ds_read_b128 v[116:119], v240 offset:1024
    s_nop 5
    v_mov_b32 v13, v68
    s_nop 1
    v_permlane32_swap_b32 v68, v13
    s_waitcnt lgkmcnt(2)
    v_add_f32 v68, v68, v120
    v_rcp_f32 v12, v68
    v_cmp_nle_f32 s[6:7], s4, v68
    v_cmp_nge_f32 vcc, s5, v68
    v_mul_f32 v12, v12, v108
    s_waitcnt lgkmcnt(0)
    v_pk_add_f32 v[60:61], v[60:61], v[112:113]
    v_pk_add_f32 v[62:63], v[62:63], v[114:115]
    v_pk_add_f32 v[64:65], v[64:65], v[116:117]
    v_pk_add_f32 v[66:67], v[66:67], v[118:119]
    s_or_b64 s[6:7], s[6:7], vcc
    v_pk_add_f32 v[14:15], v[60:61], v[62:63]
    v_pk_add_f32 v[16:17], v[64:65], v[66:67]
    v_pk_add_f32 v[14:15], v[14:15], v[16:17]
    v_add_f32 v14, v14, v15
    v_cmp_class_f32 vcc, v14, s3
    s_or_b64 s[6:7], s[6:7], vcc
    s_cbranch_scc1 L_slow
L_fin:
    v_pk_mul_f32 v[60:61], v[60:61], v[12:13] op_sel_hi:[1,0]
    v_pk_mul_f32 v[62:63], v[62:63], v[12:13] op_sel_hi:[1,0]
    v_pk_mul_f32 v[64:65], v[64:65], v[12:13] op_sel_hi:[1,0]
    v_pk_mul_f32 v[66:67], v[66:67], v[12:13] op_sel_hi:[1,0]
    v_cvt_pk_bf16_f32 v60, v60, v61
    v_cvt_pk_bf16_f32 v61, v62, v63
    v_cvt_pk_bf16_f32 v62, v64, v65
    v_cvt_pk_bf16_f32 v63, v66, v67
    v_min_u32 v60, -2, v60
    v_min_u32 v63, -2, v63
    buffer_store_dwordx4 v[60:63], v2, s[8:11], s80 offen sc1
    ds_read_b64_tr_b16 v[208:209], v237 offset:0
    ds_read_b64_tr_b16 v[210:211], v237 offset:1024
    ds_read_b64_tr_b16 v[212:213], v238 offset:0
    ds_read_b64_tr_b16 v[214:215], v238 offset:1024
    ds_read_b64_tr_b16 v[216:217], v237 offset:2048
    ds_read_b64_tr_b16 v[218:219], v237 offset:3072
    ds_read_b64_tr_b16 v[220:221], v238 offset:2048
    ds_read_b64_tr_b16 v[222:223], v238 offset:3072
    s_waitcnt lgkmcnt(4)
    v_mfma_f32_32x32x16_bf16 v[176:191], v[208:211], v[144:147], 0
    ds_read_b64_tr_b16 v[104:105], v237 offset:4096
    ds_read_b64_tr_b16 v[106:107], v237 offset:5120
    ds_read_b64_tr_b16 v[108:109], v238 offset:4096
    ds_read_b64_tr_b16 v[110:111], v238 offset:5120
    v_mfma_f32_32x32x16_bf16 v[192:207], v[212:215], v[144:147], 0
    s_waitcnt lgkmcnt(4)
    v_mfma_f32_32x32x16_bf16 v[176:191], v[216:219], v[148:151], v[176:191]
    ds_read_b64_tr_b16 v[208:209], v237 offset:6144
    ds_read_b64_tr_b16 v[210:211], v237 offset:7168
    ds_read_b64_tr_b16 v[212:213], v238 offset:6144
    ds_read_b64_tr_b16 v[214:215], v238 offset:7168
    v_mfma_f32_32x32x16_bf16 v[192:207], v[220:223], v[148:151], v[192:207]
    s_waitcnt lgkmcnt(4)
    v_mfma_f32_32x32x16_bf16 v[176:191], v[104:107], v[152:155], v[176:191]
    ds_read_b64_tr_b16 v[216:217], v237 offset:8192
    ds_read_b64_tr_b16 v[218:219], v237 offset:9216
    ds_read_b64_tr_b16 v[220:221], v238 offset:8192
    ds_read_b64_tr_b16 v[222:223], v238 offset:9216
    v_mfma_f32_32x32x16_bf16 v[192:207], v[108:111], v[152:155], v[192:207]
    s_waitcnt lgkmcnt(4)
    v_mfma_f32_32x32x16_bf16 v[176:191], v[208:211], v[156:159], v[176:191]
    ds_read_b64_tr_b16 v[104:105], v237 offset:10240
    ds_read_b64_tr_b16 v[106:107], v237 offset:11264
    ds_read_b64_tr_b16 v[108:109], v238 offset:10240
    ds_read_b64_tr_b16 v[110:111], v238 offset:11264
    v_mfma_f32_32x32x16_bf16 v[192:207], v[212:215], v[156:159], v[192:207]
    s_waitcnt lgkmcnt(4)
    v_mfma_f32_32x32x16_bf16 v[176:191], v[216:219], v[160:163], v[176:191]
    ds_read_b64_tr_b16 v[208:209], v237 offset:12288
    ds_read_b64_tr_b16 v[210:211], v237 offset:13312
    ds_read_b64_tr_b16 v[212:213], v238 offset:12288
    ds_read_b64_tr_b16 v[214:215], v238 offset:13312
    v_mfma_f32_32x32x16_bf16 v[192:207], v[220:223], v[160:163], v[192:207]
    s_waitcnt lgkmcnt(4)
    v_mfma_f32_32x32x16_bf16 v[176:191], v[104:107], v[164:167], v[176:191]
    ds_read_b64_tr_b16 v[216:217], v237 offset:14336
    ds_read_b64_tr_b16 v[218:219], v237 offset:15360
    ds_read_b64_tr_b16 v[220:221], v238 offset:14336
    ds_read_b64_tr_b16 v[222:223], v238 offset:15360
    v_mfma_f32_32x32x16_bf16 v[192:207], v[108:111], v[164:167], v[192:207]
    s_waitcnt lgkmcnt(4)
    v_mfma_f32_32x32x16_bf16 v[176:191], v[208:211], v[168:171], v[176:191]
    v_mfma_f32_32x32x16_bf16 v[192:207], v[212:215], v[168:171], v[192:207]
    s_waitcnt lgkmcnt(0)
    v_mfma_f32_32x32x16_bf16 v[176:191], v[216:219], v[172:175], v[176:191]
    v_mfma_f32_32x32x16_bf16 v[192:207], v[220:223], v[172:175], v[192:207]
    s_cmp_eq_u32 s70, 3
    s_mov_b32 s50, 0x10000
    s_cselect_b32 s50, 0x18000, s50
    v_add_u32 v237, s50, v237
    v_add_u32 v238, s50, v238
    s_mov_b32 s3, 0
    buffer_load_dwordx4 v[4:7], v2, s[8:11], s88 offen offset:0 sc1
    buffer_load_dwordx4 v[8:11], v2, s[8:11], s88 offen offset:1024 sc1
    buffer_load_dwordx4 v[12:15], v2, s[8:11], s88 offen offset:2048 sc1
    buffer_load_dwordx4 v[16:19], v2, s[8:11], s88 offen offset:3072 sc1
    buffer_load_dwordx4 v[20:23], v2, s[8:11], s89 offen offset:0 sc1
    buffer_load_dwordx4 v[24:27], v2, s[8:11], s89 offen offset:1024 sc1
    buffer_load_dwordx4 v[28:31], v2, s[8:11], s89 offen offset:2048 sc1
    buffer_load_dwordx4 v[32:35], v2, s[8:11], s89 offen offset:3072 sc1
    s_barrier
    ds_read_b64_tr_b16 v[208:209], v237 offset:0
    ds_read_b64_tr_b16 v[210:211], v237 offset:1024
    ds_read_b64_tr_b16 v[212:213], v238 offset:0
    ds_read_b64_tr_b16 v[214:215], v238 offset:1024
    ds_read_b64_tr_b16 v[216:217], v237 offset:2048
    ds_read_b64_tr_b16 v[218:219], v237 offset:3072
    ds_read_b64_tr_b16 v[220:221], v238 offset:2048
    ds_read_b64_tr_b16 v[222:223], v238 offset:3072
    v_xor_b32 v36, 16, v242
    v_xor_b32 v37, 32, v242
    v_xor_b32 v38, 48, v242
    v_xor_b32 v39, 64, v242
    v_xor_b32 v40, 80, v242
    v_xor_b32 v41, 96, v242
    v_xor_b32 v42, 112, v242
    s_waitcnt vmcnt(7)
L_oa0_chk:
    v_max_u32 v43, v4, v7
    v_cmp_eq_u32 vcc, -1, v43
    s_waitcnt lgkmcnt(4)
    s_cbranch_vccnz L_oa0_retry
L_oa0_ok:
    v_mfma_f32_32x32x16_bf16 v[176:191], v[208:211], v[4:7], v[176:191]
    ds_read_b64_tr_b16 v[104:105], v237 offset:4096
    ds_read_b64_tr_b16 v[106:107], v237 offset:5120
    ds_read_b64_tr_b16 v[108:109], v238 offset:4096
    ds_read_b64_tr_b16 v[110:111], v238 offset:5120
    v_mfma_f32_32x32x16_bf16 v[192:207], v[212:215], v[4:7], v[192:207]
    s_waitcnt vmcnt(6)
L_oa1_chk:
    v_max_u32 v43, v8, v11
    v_cmp_eq_u32 vcc, -1, v43
    s_waitcnt lgkmcnt(4)
    s_cbranch_vccnz L_oa1_retry
L_oa1_ok:
    v_mfma_f32_32x32x16_bf16 v[176:191], v[216:219], v[8:11], v[176:191]
    ds_read_b64_tr_b16 v[208:209], v237 offset:6144
    ds_read_b64_tr_b16 v[210:211], v237 offset:7168
    ds_read_b64_tr_b16 v[212:213], v238 offset:6144
    ds_read_b64_tr_b16 v[214:215], v238 offset:7168
    v_mfma_f32_32x32x16_bf16 v[192:207], v[220:223], v[8:11], v[192:207]
    s_waitcnt vmcnt(5)
L_oa2_chk:
    v_max_u32 v43, v12, v15
    v_cmp_eq_u32 vcc, -1, v43
    s_waitcnt lgkmcnt(4)
    s_cbranch_vccnz L_oa2_retry
L_oa2_ok:
    v_mfma_f32_32x32x16_bf16 v[176:191], v[104:107], v[12:15], v[176:191]
    ds_read_b64_tr_b16 v[216:217], v237 offset:8192
    ds_read_b64_tr_b16 v[218:219], v237 offset:9216
    ds_read_b64_tr_b16 v[220:221], v238 offset:8192
    ds_read_b64_tr_b16 v[222:223], v238 offset:9216
    v_mfma_f32_32x32x16_bf16 v[192:207], v[108:111], v[12:15], v[192:207]
    s_waitcnt vmcnt(4)
L_oa3_chk:
    v_max_u32 v43, v16, v19
    v_cmp_eq_u32 vcc, -1, v43
    s_waitcnt lgkmcnt(4)
    s_cbranch_vccnz L_oa3_retry
L_oa3_ok:
    v_mfma_f32_32x32x16_bf16 v[176:191], v[208:211], v[16:19], v[176:191]
    ds_read_b64_tr_b16 v[104:105], v237 offset:10240
    ds_read_b64_tr_b16 v[106:107], v237 offset:11264
    ds_read_b64_tr_b16 v[108:109], v238 offset:10240
    ds_read_b64_tr_b16 v[110:111], v238 offset:11264
    v_mfma_f32_32x32x16_bf16 v[192:207], v[212:215], v[16:19], v[192:207]
    s_waitcnt vmcnt(3)
L_oa4_chk:
    v_max_u32 v43, v20, v23
    v_cmp_eq_u32 vcc, -1, v43
    s_waitcnt lgkmcnt(4)
    s_cbranch_vccnz L_oa4_retry
L_oa4_ok:
    v_mfma_f32_32x32x16_bf16 v[176:191], v[216:219], v[20:23], v[176:191]
    ds_read_b64_tr_b16 v[208:209], v237 offset:12288
    ds_read_b64_tr_b16 v[210:211], v237 offset:13312
    ds_read_b64_tr_b16 v[212:213], v238 offset:12288
    ds_read_b64_tr_b16 v[214:215], v238 offset:13312
    v_mfma_f32_32x32x16_bf16 v[192:207], v[220:223], v[20:23], v[192:207]
    s_waitcnt vmcnt(2)
L_oa5_chk:
    v_max_u32 v43, v24, v27
    v_cmp_eq_u32 vcc, -1, v43
    s_waitcnt lgkmcnt(4)
    s_cbranch_vccnz L_oa5_retry
L_oa5_ok:
    v_mfma_f32_32x32x16_bf16 v[176:191], v[104:107], v[24:27], v[176:191]
    ds_read_b64_tr_b16 v[216:217], v237 offset:14336
    ds_read_b64_tr_b16 v[218:219], v237 offset:15360
    ds_read_b64_tr_b16 v[220:221], v238 offset:14336
    ds_read_b64_tr_b16 v[222:223], v238 offset:15360
    v_mfma_f32_32x32x16_bf16 v[192:207], v[108:111], v[24:27], v[192:207]
    s_waitcnt vmcnt(1)
L_oa6_chk:
    v_max_u32 v43, v28, v31
    v_cmp_eq_u32 vcc, -1, v43
    s_waitcnt lgkmcnt(4)
    s_cbranch_vccnz L_oa6_retry
L_oa6_ok:
    v_mfma_f32_32x32x16_bf16 v[176:191], v[208:211], v[28:31], v[176:191]
    v_mfma_f32_32x32x16_bf16 v[192:207], v[212:215], v[28:31], v[192:207]
    s_waitcnt vmcnt(0)
L_oa7_chk:
    v_max_u32 v43, v32, v35
    v_cmp_eq_u32 vcc, -1, v43
    s_waitcnt lgkmcnt(0)
    s_cbranch_vccnz L_oa7_retry
L_oa7_ok:
    v_mfma_f32_32x32x16_bf16 v[176:191], v[216:219], v[32:35], v[176:191]
    v_mfma_f32_32x32x16_bf16 v[192:207], v[220:223], v[32:35], v[192:207]
    s_nop 10
    ds_write_b128 v242, v[176:179]
    ds_write_b128 v36, v[180:183]
    ds_write_b128 v37, v[184:187]
    ds_write_b128 v38, v[188:191]
    ds_write_b128 v39, v[192:195]
    ds_write_b128 v40, v[196:199]
    ds_write_b128 v41, v[200:203]
    ds_write_b128 v42, v[204:207]
    s_waitcnt lgkmcnt(0)
    s_barrier
    ds_read_b128 v[48:51], v243 offset:0
    ds_read_b128 v[52:55], v244 offset:0
    ds_read_b128 v[56:59], v243 offset:16384
    ds_read_b128 v[60:63], v244 offset:16384
    ds_read_b128 v[64:67], v243 offset:32768
    ds_read_b128 v[68:71], v244 offset:32768
    ds_read_b128 v[72:75], v243 offset:49152
    ds_read_b128 v[76:79], v244 offset:49152
    s_waitcnt lgkmcnt(4)
    v_pk_add_f32 v[48:49], v[48:49], v[56:57]
    v_pk_add_f32 v[50:51], v[50:51], v[58:59]
    v_pk_add_f32 v[52:53], v[52:53], v[60:61]
    v_pk_add_f32 v[54:55], v[54:55], v[62:63]
    s_waitcnt lgkmcnt(2)
    v_pk_add_f32 v[48:49], v[48:49], v[64:65]
    v_pk_add_f32 v[50:51], v[50:51], v[66:67]
    v_pk_add_f32 v[52:53], v[52:53], v[68:69]
    v_pk_add_f32 v[54:55], v[54:55], v[70:71]
    s_waitcnt lgkmcnt(0)
    v_pk_add_f32 v[48:49], v[48:49], v[72:73]
    v_pk_add_f32 v[50:51], v[50:51], v[74:75]
    v_pk_add_f32 v[52:53], v[52:53], v[76:77]
    v_pk_add_f32 v[54:55], v[54:55], v[78:79]
    v_cvt_pk_bf16_f32 v48, v48, v49
    v_cvt_pk_bf16_f32 v49, v50, v51
    v_cvt_pk_bf16_f32 v50, v52, v53
    v_cvt_pk_bf16_f32 v51, v54, v55
    buffer_store_dwordx4 v[48:51], v245, s[36:39], s90 offen sc1
    s_or_b32 s50, s2, s44
    s_cmp_lg_u32 s50, 0
    s_cbranch_scc1 L_noadv
    v_mov_b32 v5, 14909440
    s_mov_b64 exec, 1
    buffer_store_dword v251, v5, s[8:11], 0 offen sc1
    s_mov_b64 exec, -1
L_noadv:
    s_endpgm
.p2align 5
L_f2_spin:
    buffer_load_dword v103, v230, s[8:11], s75 offen sc1
    s_add_u32 s50, s50, 1
    s_cmp_gt_u32 s50, 60000
    s_waitcnt vmcnt(0)
    v_cmp_ne_u32 vcc, s49, v103
    s_cbranch_scc1 L_f2_ok
    s_cbranch_vccnz L_f2_spin
    s_branch L_f2_ok
L_f3_spin:
    buffer_load_dword v103, v231, s[8:11], s85 offen sc1
    s_add_u32 s50, s50, 1
    s_cmp_gt_u32 s50, 60000
    s_waitcnt vmcnt(0)
    v_cmp_ne_u32 vcc, s49, v103
    s_cbranch_scc1 L_f3_ok
    s_cbranch_vccnz L_f3_spin
    s_branch L_f3_ok
L_oa0_retry:
    s_call_b64 s[4:5], L_refetch
    s_waitcnt vmcnt(0)
    s_cbranch_scc1 L_oa0_ok
    s_branch L_oa0_chk
L_oa1_retry:
    s_call_b64 s[4:5], L_refetch
    s_waitcnt vmcnt(0)
    s_cbranch_scc1 L_oa1_ok
    s_branch L_oa1_chk
L_oa2_retry:
    s_call_b64 s[4:5], L_refetch
    s_waitcnt vmcnt(0)
    s_cbranch_scc1 L_oa2_ok
    s_branch L_oa2_chk
L_oa3_retry:
    s_call_b64 s[4:5], L_refetch
    s_waitcnt vmcnt(0)
    s_cbranch_scc1 L_oa3_ok
    s_branch L_oa3_chk
L_oa4_retry:
    s_call_b64 s[4:5], L_refetch
    s_waitcnt vmcnt(0)
    s_cbranch_scc1 L_oa4_ok
    s_branch L_oa4_chk
L_oa5_retry:
    s_call_b64 s[4:5], L_refetch
    s_waitcnt vmcnt(0)
    s_cbranch_scc1 L_oa5_ok
    s_branch L_oa5_chk
L_oa6_retry:
    s_call_b64 s[4:5], L_refetch
    s_waitcnt vmcnt(0)
    s_cbranch_scc1 L_oa6_ok
    s_branch L_oa6_chk
L_oa7_retry:
    s_call_b64 s[4:5], L_refetch
    s_waitcnt vmcnt(0)
    s_cbranch_scc1 L_oa7_ok
    s_branch L_oa7_chk
L_refetch:
    s_waitcnt vmcnt(0)
    v_max_u32 v43, v4, v7
    v_cmp_eq_u32 vcc, -1, v43
    s_nop 0
    s_cbranch_vccz L_rf0
    buffer_load_dwordx4 v[4:7], v2, s[8:11], s88 offen offset:0 sc1
L_rf0:
    v_max_u32 v43, v8, v11
    v_cmp_eq_u32 vcc, -1, v43
    s_nop 0
    s_cbranch_vccz L_rf1
    buffer_load_dwordx4 v[8:11], v2, s[8:11], s88 offen offset:1024 sc1
L_rf1:
    v_max_u32 v43, v12, v15
    v_cmp_eq_u32 vcc, -1, v43
    s_nop 0
    s_cbranch_vccz L_rf2
    buffer_load_dwordx4 v[12:15], v2, s[8:11], s88 offen offset:2048 sc1
L_rf2:
    v_max_u32 v43, v16, v19
    v_cmp_eq_u32 vcc, -1, v43
    s_nop 0
    s_cbranch_vccz L_rf3
    buffer_load_dwordx4 v[16:19], v2, s[8:11], s88 offen offset:3072 sc1
L_rf3:
    v_max_u32 v43, v20, v23
    v_cmp_eq_u32 vcc, -1, v43
    s_nop 0
    s_cbranch_vccz L_rf4
    buffer_load_dwordx4 v[20:23], v2, s[8:11], s89 offen offset:0 sc1
L_rf4:
    v_max_u32 v43, v24, v27
    v_cmp_eq_u32 vcc, -1, v43
    s_nop 0
    s_cbranch_vccz L_rf5
    buffer_load_dwordx4 v[24:27], v2, s[8:11], s89 offen offset:1024 sc1
L_rf5:
    v_max_u32 v43, v28, v31
    v_cmp_eq_u32 vcc, -1, v43
    s_nop 0
    s_cbranch_vccz L_rf6
    buffer_load_dwordx4 v[28:31], v2, s[8:11], s89 offen offset:2048 sc1
L_rf6:
    v_max_u32 v43, v32, v35
    v_cmp_eq_u32 vcc, -1, v43
    s_nop 0
    s_cbranch_vccz L_rf7
    buffer_load_dwordx4 v[32:35], v2, s[8:11], s89 offen offset:3072 sc1
L_rf7:
    s_add_u32 s3, s3, 1
    s_cmp_gt_u32 s3, 60000
    s_setpc_b64 s[4:5]
L_slow:
    v_mov_b32 v12, 0xff800000
    v_and_b32 v7, 15, v1
    v_lshrrev_b32 v5, 5, v1
    v_lshl_add_u32 v7, v5, 4, v7
    v_lshlrev_b32 v7, 4, v7
    s_add_u32 s4, s59, 2097152
    s_add_u32 s5, s59, 4194304
    s_mov_b32 s3, 0
    v_mov_b32 v60, 0
    v_mov_b32 v61, 0
    v_mov_b32 v62, 0
    v_mov_b32 v63, 0
    v_mov_b32 v64, 0
    v_mov_b32 v65, 0
    v_mov_b32 v66, 0
    v_mov_b32 v67, 0
    v_mov_b32 v68, 0
    v_mov_b32 v69, 0
    v_mov_b32 v70, 0
    v_mov_b32 v71, 0
    v_mov_b32 v72, 0
    v_mov_b32 v73, 0
    v_mov_b32 v74, 0
    v_mov_b32 v75, 0
L_slow_loop:
    buffer_load_dwordx4 v[76:79], v2, s[8:11], s4 offen sc1
    s_mov_b64 exec, s[56:57]
    buffer_load_dwordx4 v[84:87], v7, s[8:11], s5 offen sc1
    buffer_load_dwordx4 v[88:91], v7, s[8:11], s5 offen offset:512 sc1
    s_mov_b64 exec, -1
    s_waitcnt vmcnt(0)
    v_mfma_f32_32x32x16_bf16 v[20:35], v[76:79], v[40:43], 0
    s_nop 11
    v_max3_f32 v13, v12, v20, v21
    v_max3_f32 v13, v13, v22, v23
    v_max3_f32 v13, v13, v24, v25
    v_max3_f32 v13, v13, v26, v27
    v_max3_f32 v13, v13, v28, v29
    v_max3_f32 v13, v13, v30, v31
    v_max3_f32 v13, v13, v32, v33
    v_max3_f32 v13, v13, v34, v35
    v_mov_b32 v14, v13
    s_nop 1
    v_permlane32_swap_b32 v14, v13
    v_max_f32 v13, v13, v14
    v_sub_f32 v14, v12, v13
    v_exp_f32 v14, v14
    v_mov_b32 v12, v13
    v_sub_f32 v20, v20, v13
    v_sub_f32 v21, v21, v13
    v_sub_f32 v22, v22, v13
    v_sub_f32 v23, v23, v13
    v_sub_f32 v24, v24, v13
    v_sub_f32 v25, v25, v13
    v_sub_f32 v26, v26, v13
    v_sub_f32 v27, v27, v13
    v_sub_f32 v28, v28, v13
    v_sub_f32 v29, v29, v13
    v_sub_f32 v30, v30, v13
    v_sub_f32 v31, v31, v13
    v_sub_f32 v32, v32, v13
    v_sub_f32 v33, v33, v13
    v_sub_f32 v34, v34, v13
    v_sub_f32 v35, v35, v13
    v_exp_f32 v20, v20
    v_exp_f32 v21, v21
    v_exp_f32 v22, v22
    v_exp_f32 v23, v23
    v_exp_f32 v24, v24
    v_exp_f32 v25, v25
    v_exp_f32 v26, v26
    v_exp_f32 v27, v27
    v_exp_f32 v28, v28
    v_exp_f32 v29, v29
    v_exp_f32 v30, v30
    v_exp_f32 v31, v31
    v_exp_f32 v32, v32
    v_exp_f32 v33, v33
    v_exp_f32 v34, v34
    v_exp_f32 v35, v35
    v_mul_f32 v60, v60, v14
    v_mul_f32 v61, v61, v14
    v_mul_f32 v62, v62, v14
    v_mul_f32 v63, v63, v14
    v_mul_f32 v64, v64, v14
    v_mul_f32 v65, v65, v14
    v_mul_f32 v66, v66, v14
    v_mul_f32 v67, v67, v14
    v_mul_f32 v68, v68, v14
    s_nop 1
    v_smfmac_f32_32x32x32_bf16 v[60:75], v[84:87], v[20:27], v3
    v_smfmac_f32_32x32x32_bf16 v[60:75], v[88:91], v[28:35], v3
    s_add_u32 s4, s4, 1024
    s_add_u32 s5, s5, 1024
    s_add_u32 s3, s3, 1
    s_nop 7
    s_cmp_lt_u32 s3, 64
    s_cbranch_scc1 L_slow_loop
    v_mov_b32 v13, v68
    s_nop 1
    v_permlane32_swap_b32 v68, v13
    v_rcp_f32 v12, v68
    s_nop 0
    v_mul_f32 v12, v12, v108
    s_branch L_fin
L_end:
    s_endpgm
.section .rodata,"a"
.p2align 6
.amdhsa_kernel gated_mix__mha_block__linear_attn_block__prompt_kernel
  .amdhsa_next_free_vgpr 256
  .amdhsa_next_free_sgpr 102
  .amdhsa_accum_offset 256
  .amdhsa_group_segment_fixed_size 0
  .amdhsa_kernarg_size 80
  .amdhsa_user_sgpr_count 2
  .amdhsa_user_sgpr_kernarg_segment_ptr 1
  .amdhsa_system_sgpr_workgroup_id_x 1
.end_amdhsa_kernel
```
